```python
import torch

def _softmax(x, axis=-1):
    return torch.softmax(x, dim=axis)
def _gelu(x):
    return torch.nn.functional.gelu(x, approximate="tanh")
def _silu(x):
    return torch.nn.functional.silu(x)
def _sigmoid(x):
    return torch.sigmoid(x)
def _layernorm(x, axis=-1, eps=1e-5):
    m = x.mean(dim=axis, keepdim=True)
    v = x.var(dim=axis, keepdim=True, unbiased=False)
    return (x - m) / torch.sqrt(v + eps)
def _scatter_add(tgt, idx, src, axis=0):
    return tgt.clone().index_add_(axis, idx, src)
def _segment_sum(src, seg, n):
    out = torch.zeros((n,) + src.shape[1:], dtype=src.dtype)
    return out.index_add_(0, seg, src)
def _pad(x, pw):
    flat = tuple(v for pair in reversed(pw) for v in pair)
    return torch.nn.functional.pad(x, flat)

kernel_name = 'gated_mix__softmax_full_mha__softmax_full_mha__prompt'

def setup_inputs():

    _w = (lambda a: (lambda t: t.to(torch.bfloat16) if t.is_floating_point() else t)(torch.as_tensor(a)))
    def _A_setup():
        B, S, D = 1, 2048, 512
        return {
            "x": _w((lambda *s: torch.randn(*s, dtype=torch.bfloat16) * 0.05)(B, S, D)),
            "wqkv": _w((lambda *s: torch.randn(*s, dtype=torch.bfloat16) * 0.8)(D, 3 * D)),
            "wo": _w((lambda *s: torch.randn(*s, dtype=torch.bfloat16) * 0.05)(D, D)),
        }
    _A_in = _A_setup()

    def _B_setup():
        B, S, D = 1, 2048, 512
        return {
            "x": _w((lambda *s: torch.randn(*s, dtype=torch.bfloat16) * 0.05)(B, S, D)),
            "wqkv": _w((lambda *s: torch.randn(*s, dtype=torch.bfloat16) * 0.8)(D, 3 * D)),
            "wo": _w((lambda *s: torch.randn(*s, dtype=torch.bfloat16) * 0.05)(D, D)),
        }
    _B_in = _B_setup()

    return {
        "A_x": _A_in["x"],
        "A_wqkv": _A_in["wqkv"],
        "A_wo": _A_in["wo"],
        "B_x": _B_in["x"],
        "B_wqkv": _B_in["wqkv"],
        "B_wo": _B_in["wo"],
        "gate_w": _w((lambda *s: torch.randn(*s, dtype=torch.bfloat16) * 0.05)(512) * 16.0),
    }

def reference(A_x, A_wqkv, A_wo, B_x, B_wqkv, B_wo, gate_w):
    def _A_ref(x, wqkv, wo):
        B, S, D = x.shape
        H = 32; Dh = D // H
        qkv = (lambda x, *d: x.permute(*d))((x @ wqkv).reshape(B, S, 3, H, Dh), 2, 0, 3, 1, 4)
        q, k, v = qkv[0], qkv[1], qkv[2]
        scale = Dh ** -0.5
        scores = torch.einsum("bhqd,bhkd->bhqk", q, k) * scale
        p = _softmax(scores, axis=-1)
        o = torch.einsum("bhqk,bhkd->bhqd", p, v)
        return (lambda x, *d: x.permute(*d))(o, 0, 2, 1, 3).reshape(B, S, D) @ wo

    def _B_ref(x, wqkv, wo):
        B, S, D = x.shape
        H = 32; Dh = D // H
        qkv = (lambda x, *d: x.permute(*d))((x @ wqkv).reshape(B, S, 3, H, Dh), 2, 0, 3, 1, 4)
        q, k, v = qkv[0], qkv[1], qkv[2]
        scale = Dh ** -0.5
        scores = torch.einsum("bhqd,bhkd->bhqk", q, k) * scale
        p = _softmax(scores, axis=-1)
        o = torch.einsum("bhqk,bhkd->bhqd", p, v)
        return (lambda x, *d: x.permute(*d))(o, 0, 2, 1, 3).reshape(B, S, D) @ wo

    x = A_x
    g = _sigmoid((x * gate_w).sum(-1, keepdims=True))
    a = _A_ref(x, A_wqkv, A_wo)
    b = _B_ref(x, B_wqkv, B_wo)
    return g * a + (1 - g) * b
```

```asm
; @launch grid=(256,1,1) block=(512,1,1) lds=155712
.amdgcn_target "amdgcn-amd-amdhsa--gfx950"
.text
.globl gated_mix__softmax_full_mha__softmax_full_mha__prompt_kernel
.p2align 8
.type gated_mix__softmax_full_mha__softmax_full_mha__prompt_kernel,@function
gated_mix__softmax_full_mha__softmax_full_mha__prompt_kernel:
    s_cmp_ge_u32 s2, 256
    s_cbranch_scc1 gated_mix__softmax_full_mha__softmax_full_mha__prompt_kernel_exit
    s_load_dwordx16 s[4:19], s[0:1], 0
    s_load_dwordx4 s[20:23], s[0:1], 64
    v_lshrrev_b32 v1, 6, v0
    v_and_b32 v0, 63, v0
    v_readfirstlane_b32 s3, v1
    s_and_b32 s59, s2, 7
    s_lshr_b32 s60, s2, 3
    s_and_b32 s61, s60, 3
    s_lshl_b32 s59, s59, 2
    s_or_b32 s52, s59, s61
    s_lshr_b32 s53, s60, 2
    s_mov_b32 s54, 0x56317420
    s_cmp_eq_u32 s61, 1
    s_cselect_b32 s54, 0x75041362, s54
    s_cmp_eq_u32 s61, 2
    s_cselect_b32 s54, 0x56317420, s54
    s_cmp_eq_u32 s61, 3
    s_cselect_b32 s54, 0x35617420, s54
    s_mul_i32 s61, s53, 0x11111111
    s_add_u32 s54, s54, s61
    s_and_b32 s54, s54, 0x77777777
    v_lshrrev_b32 v16, 3, v0
    v_and_b32 v17, 7, v0
    v_lshrrev_b32 v18, 4, v0
    v_xor_b32 v18, v17, v18
    v_lshlrev_b32 v18, 4, v18
    v_lshl_add_u32 v2, v16, 10, v18
    v_xor_b32 v18, 64, v2
    v_add_u32 v3, 7168, v18
    v_add_u32 v4, 14336, v2
    v_add_u32 v5, 21504, v18
    v_lshrrev_b32 v18, 2, v0
    v_mul_u32_u24 v18, 3072, v18
    v_and_b32 v19, 3, v0
    v_lshl_add_u32 v6, v19, 4, v18
    v_lshlrev_b32 v1, 4, v0
    s_lshl_b32 s55, s53, 18
    s_lshl_b32 s59, s3, 15
    s_add_u32 s55, s55, s59
    s_lshl_b32 s57, s3, 12
    s_and_b32 s59, s3, 3
    s_mul_i32 s58, s59, 3072
    s_lshl_b32 s56, s58, 4
    s_add_u32 s58, s58, 98304
    s_and_b32 s59, s52, 15
    s_lshl_b32 s59, s59, 6
    s_add_u32 s56, s56, s59
    s_cmp_ge_u32 s52, 16
    s_waitcnt lgkmcnt(0)

    s_cselect_b32 s28, s12, s6
    s_cselect_b32 s29, s13, s7
    s_mov_b32 s30, 1572864
    s_mov_b32 s31, 0x20000

    s_mov_b32 s24, s4
    s_mov_b32 s25, s5
    s_mov_b32 s26, 2097152
    s_mov_b32 s27, 0x20000
    s_mov_b32 s32, s22
    s_mov_b32 s33, s23
    s_mov_b32 s34, 13811712
    s_mov_b32 s35, 0x20000
    s_cmp_ge_u32 s3, 4
    s_cbranch_scc1 gated_mix__softmax_full_mha__softmax_full_mha__prompt_kernel_loader

    s_bfe_u32 s59, s54, 0x30000
    s_lshl_b32 s60, s59, 7
    s_add_u32 s60, s60, s55
    s_mul_i32 s61, s59, 196608

    s_add_u32 m0, s57, 0
    s_add_u32 s61, s61, s56
    buffer_load_dwordx4 v2, s[24:27], s60 offen offset:0 lds
    buffer_load_dwordx4 v3, s[24:27], s60 offen offset:1024 lds
    buffer_load_dwordx4 v4, s[24:27], s60 offen offset:2048 lds
    buffer_load_dwordx4 v5, s[24:27], s60 offen offset:3072 lds
    s_add_u32 m0, s58, 0
    s_nop 0
    buffer_load_dwordx4 v6, s[28:31], s61 offen offset:0 lds
    buffer_load_dwordx4 v6, s[28:31], s61 offen offset:1024 lds
    s_cmp_ge_u32 s2, 128
    s_cselect_b32 s36, s14, s8
    s_cselect_b32 s37, s15, s9
    s_mov_b32 s38, 524288
    s_mov_b32 s39, 0x20000

    s_mov_b32 s40, s18
    s_mov_b32 s41, s19
    s_mov_b32 s42, 2097152
    s_mov_b32 s43, 0x20000
    s_mov_b32 s44, s16
    s_mov_b32 s45, s17
    s_mov_b32 s46, 1024
    s_mov_b32 s47, 0x20000
    s_mov_b32 s48, s20
    s_mov_b32 s49, s21
    s_mov_b32 s50, 256
    s_mov_b32 s51, 0x20000
    s_lshl_b32 s59, s52, 18
    s_lshl_b32 s60, s3, 12
    s_add_u32 s4, s59, s60
    s_add_u32 s6, s60, 32768
    s_lshl_b32 s61, s53, 15
    s_add_u32 s16, s59, s61
    s_add_u32 s17, s16, 16384
    s_and_b32 s5, s61, 0
    s_cmp_eq_u32 s5, s61
    s_cselect_b32 s62, 32768, 0
    s_add_u32 s5, s5, s62
    s_mov_b32 s7, 32768
    s_lshl_b32 s9, s52, 8
    s_add_u32 s9, s9, 13762560
    s_lshr_b32 s60, s3, 2
    s_and_b32 s12, s2, 7
    s_lshl_b32 s12, s12, 8
    s_add_u32 s12, s12, 13770752
    s_lshl_b32 s61, s60, 5
    s_add_u32 s61, s61, s52
    s_lshl_b32 s10, s61, 10
    s_lshl_b32 s61, s53, 2
    s_and_b32 s62, s3, 3
    s_add_u32 s61, s61, s62
    s_lshl_b32 s62, s61, 17
    s_add_u32 s10, s10, s62
    s_add_u32 s10, s10, 8388608
    s_add_u32 s11, s10, 65536
    s_lshr_b32 s62, s52, 3
    s_lshl_b32 s62, s62, 5
    s_add_u32 s61, s61, s62
    s_lshl_b32 s20, s61, 10
    s_add_u32 s20, s20, 13631488
    s_and_b32 s61, s2, 7
    s_lshl_b32 s61, s61, 2
    s_lshr_b32 s62, s2, 6
    s_add_u32 s14, s61, s62
    s_bfe_u32 s15, s2, 0x30003
    s_lshr_b32 s61, s3, 1
    s_lshl_b32 s13, s15, 17
    s_lshl_b32 s62, s61, 15
    s_add_u32 s13, s13, s62
    s_add_u32 s13, s13, 12582912
    s_lshl_b32 s21, s14, 17
    s_lshl_b32 s62, s61, 14
    s_add_u32 s21, s21, s62
    s_and_b32 s62, s3, 1
    s_lshl_b32 s63, s62, 16
    s_add_u32 s21, s21, s63
    s_add_u32 s21, s21, 8388608
    s_lshl_b32 s22, s14, 16
    s_lshl_b32 s63, s62, 15
    s_add_u32 s22, s22, s63
    s_lshl_b32 s63, s15, 7
    s_add_u32 s22, s22, s63
    s_and_b32 s63, s61, 1
    s_lshl_b32 s63, s63, 14
    s_add_u32 s22, s22, s63
    s_mov_b32 s18, 0
    s_lshl_b32 s60, s60, 14
    v_add_u32 v155, s60, v1
    v_and_b32 v16, 15, v0
    v_lshlrev_b32 v16, 4, v16
    v_lshrrev_b32 v17, 5, v0
    v_lshl_or_b32 v16, v17, 8, v16
    v_bfe_u32 v17, v0, 4, 1
    v_xor_b32 v157, 1, v17
    s_add_u32 s60, s60, 8192
    v_mov_b32 v18, s60
    v_mov_b32 v19, 135168
    v_cmp_eq_u32 vcc, 0, v17
    v_mov_b32 v158, 0xdddddddd
    v_mov_b32 v161, 1
    v_cndmask_b32 v18, v19, v18, vcc
    v_add_u32 v156, v16, v18
    v_lshl_add_u32 v153, v17, 14, v16
    v_and_b32 v18, 0xb, v0
    v_cmp_eq_u32 vcc, 0, v18
    v_mov_b32 v19, 0x3f803f80
    s_lshl_b32 s60, s3, 10
    s_add_u32 s60, s60, 135168
    v_cndmask_b32 v20, 0, v19, vcc
    v_cndmask_b32 v21, 0, v19, vcc
    v_cndmask_b32 v22, 0, v19, vcc
    v_cndmask_b32 v23, 0, v19, vcc
    v_add_u32 v18, s60, v1
    ds_write_b128 v18, v[20:23]
    v_bfe_u32 v16, v0, 3, 2
    v_and_b32 v18, 7, v0
    v_lshlrev_b32 v18, 2, v18
    v_lshl_add_u32 v164, v16, 7, v18
    v_mov_b32 v159, v155
    v_mov_b32 v160, v156
    v_mov_b32 v165, 155648
    v_mov_b32 v16, 0
    v_mov_b32 v17, 0
    ds_write_b64 v165, v[16:17]

    v_mov_b32 v167, 0
    s_add_u32 s60, s2, 1
    s_and_b32 s60, s60, 3
    s_lshl_b32 s60, s60, 12
    s_add_u32 s98, s21, s60

    s_add_u32 s60, s2, 2
    s_and_b32 s60, s60, 3
    s_lshl_b32 s60, s60, 12
    s_add_u32 s99, s21, s60

    s_add_u32 s60, s2, 3
    s_and_b32 s60, s60, 3
    s_lshl_b32 s60, s60, 12
    s_add_u32 s100, s21, s60

    s_add_u32 s60, s2, 4
    s_and_b32 s60, s60, 3
    s_lshl_b32 s60, s60, 12
    s_add_u32 s101, s21, s60

    s_sub_u32 s60, s2, s15
    s_add_u32 s60, s60, 1
    s_and_b32 s60, s60, 3
    s_lshl_b32 s14, s60, 13

    v_mov_b32 v168, 0
    v_mov_b32 v169, 0
    v_mov_b32 v170, 0
    v_mov_b32 v171, 0
    v_mov_b32 v172, 0
    v_mov_b32 v173, 0
    v_mov_b32 v174, 0
    v_mov_b32 v175, 0
    v_mov_b32 v176, 0
    v_mov_b32 v177, 0
    v_mov_b32 v178, 0
    v_mov_b32 v179, 0
    v_mov_b32 v180, 0
    v_mov_b32 v181, 0
    v_mov_b32 v182, 0
    v_mov_b32 v183, 0
    v_mov_b32 v184, 0
    v_mov_b32 v185, 0
    v_mov_b32 v186, 0
    v_mov_b32 v187, 0
    v_mov_b32 v188, 0
    v_mov_b32 v189, 0
    v_mov_b32 v190, 0
    v_mov_b32 v191, 0
    v_mov_b32 v192, 0
    v_mov_b32 v193, 0
    v_mov_b32 v194, 0
    v_mov_b32 v195, 0
    v_mov_b32 v196, 0
    v_mov_b32 v197, 0
    v_mov_b32 v198, 0
    v_mov_b32 v199, 0
    s_barrier
    s_bfe_u32 s59, s54, 0x30004
    s_lshl_b32 s60, s59, 7
    s_add_u32 s60, s60, s55
    s_mul_i32 s61, s59, 196608

    s_add_u32 m0, s57, 32768
    s_add_u32 s61, s61, s56
    buffer_load_dwordx4 v2, s[24:27], s60 offen offset:0 lds
    buffer_load_dwordx4 v3, s[24:27], s60 offen offset:1024 lds
    buffer_load_dwordx4 v4, s[24:27], s60 offen offset:2048 lds
    buffer_load_dwordx4 v5, s[24:27], s60 offen offset:3072 lds
    s_add_u32 m0, s58, 12288
    s_nop 0
    buffer_load_dwordx4 v6, s[28:31], s61 offen offset:0 lds
    buffer_load_dwordx4 v6, s[28:31], s61 offen offset:1024 lds
    v_and_b32 v16, 31, v0
    v_lshrrev_b32 v17, 5, v0
    v_bfe_u32 v18, v0, 1, 3
    s_lshl_b32 s59, s3, 13
    v_lshl_add_u32 v19, v16, 7, s59

    v_or_b32 v20, 0, v17
    v_xor_b32 v20, v20, v18
    v_lshl_add_u32 v8, v20, 4, v19
    v_add_u32 v12, 0x10000, v8

    v_or_b32 v20, 2, v17
    v_xor_b32 v20, v20, v18
    v_lshl_add_u32 v9, v20, 4, v19
    v_add_u32 v13, 0x10000, v9

    v_or_b32 v20, 4, v17
    v_xor_b32 v20, v20, v18
    v_lshl_add_u32 v10, v20, 4, v19
    v_add_u32 v14, 0x10000, v10

    v_or_b32 v20, 6, v17
    v_xor_b32 v20, v20, v18
    v_lshl_add_u32 v11, v20, 4, v19
    v_add_u32 v15, 0x10000, v11

    v_bfe_u32 v20, v0, 2, 2
    v_lshlrev_b32 v21, 9, v17
    v_lshl_add_u32 v21, v20, 6, v21
    v_bfe_u32 v20, v0, 4, 1
    v_lshl_add_u32 v21, v20, 5, v21
    v_and_b32 v20, 3, v0
    v_lshl_add_u32 v21, v20, 3, v21
    v_add_u32 v7, 98304, v21
    s_lshl_b32 s59, s3, 11
    v_and_b32 v20, 0x33, v0
    v_bfe_u32 v21, v0, 2, 1
    v_lshl_or_b32 v20, v21, 3, v20
    v_bfe_u32 v21, v0, 3, 1
    v_lshl_or_b32 v20, v21, 2, v20
    v_lshl_add_u32 v152, v20, 4, s59
    s_add_u32 s60, s59, 8192
    v_add_u32 v153, s60, v153
    s_add_u32 s60, s59, 143360
    v_add_u32 v154, s60, v1
    s_mov_b32 s96, 0x3eb8aa3b
    s_mov_b32 s97, 0x3eb8aa3b

    s_waitcnt vmcnt(6) lgkmcnt(0)
    s_barrier
    ds_read_b128 v[16:19], v8 offset:0
    ds_read_b64_tr_b16 v[24:25], v7 offset:0
    ds_read_b64_tr_b16 v[26:27], v7 offset:256
    ds_read_b128 v[20:23], v8 offset:4096
    ds_read_b64_tr_b16 v[28:29], v7 offset:1024
    ds_read_b64_tr_b16 v[30:31], v7 offset:1280
    ds_read_b64_tr_b16 v[32:33], v7 offset:2048
    ds_read_b64_tr_b16 v[34:35], v7 offset:2304
    s_waitcnt lgkmcnt(0)
    v_mfma_f32_32x32x16_bf16 v[56:71], v[24:27], v[16:19], 0
    ds_read_b128 v[36:39], v9 offset:0
    ds_read_b64_tr_b16 v[44:45], v7 offset:3072
    ds_read_b64_tr_b16 v[46:47], v7 offset:3328
    v_mfma_f32_32x32x16_bf16 v[72:87], v[24:27], v[20:23], 0
    ds_read_b128 v[40:43], v9 offset:4096
    ds_read_b64_tr_b16 v[48:49], v7 offset:4096
    ds_read_b64_tr_b16 v[50:51], v7 offset:4352
    v_mfma_f32_32x32x16_bf16 v[88:103], v[28:31], v[16:19], 0
    ds_read_b64_tr_b16 v[52:53], v7 offset:5120
    ds_read_b64_tr_b16 v[54:55], v7 offset:5376
    v_mfma_f32_32x32x16_bf16 v[104:119], v[28:31], v[20:23], 0
    v_mfma_f32_32x32x16_bf16 v[120:135], v[16:19], v[32:35], 0
    v_mfma_f32_32x32x16_bf16 v[136:151], v[20:23], v[32:35], 0
    s_waitcnt lgkmcnt(0)
    v_mfma_f32_32x32x16_bf16 v[56:71], v[44:47], v[36:39], v[56:71]
    ds_read_b128 v[16:19], v10 offset:0
    ds_read_b64_tr_b16 v[24:25], v7 offset:6144
    ds_read_b64_tr_b16 v[26:27], v7 offset:6400
    v_mfma_f32_32x32x16_bf16 v[72:87], v[44:47], v[40:43], v[72:87]
    ds_read_b128 v[20:23], v10 offset:4096
    ds_read_b64_tr_b16 v[28:29], v7 offset:7168
    ds_read_b64_tr_b16 v[30:31], v7 offset:7424
    v_mfma_f32_32x32x16_bf16 v[88:103], v[48:51], v[36:39], v[88:103]
    ds_read_b64_tr_b16 v[32:33], v7 offset:8192
    ds_read_b64_tr_b16 v[34:35], v7 offset:8448
    v_mfma_f32_32x32x16_bf16 v[104:119], v[48:51], v[40:43], v[104:119]
    v_mfma_f32_32x32x16_bf16 v[120:135], v[36:39], v[52:55], v[120:135]
    v_mfma_f32_32x32x16_bf16 v[136:151], v[40:43], v[52:55], v[136:151]
    s_waitcnt lgkmcnt(0)
    v_mfma_f32_32x32x16_bf16 v[56:71], v[24:27], v[16:19], v[56:71]
    ds_read_b128 v[36:39], v11 offset:0
    ds_read_b64_tr_b16 v[44:45], v7 offset:9216
    ds_read_b64_tr_b16 v[46:47], v7 offset:9472
    v_mfma_f32_32x32x16_bf16 v[72:87], v[24:27], v[20:23], v[72:87]
    ds_read_b128 v[40:43], v11 offset:4096
    ds_read_b64_tr_b16 v[48:49], v7 offset:10240
    ds_read_b64_tr_b16 v[50:51], v7 offset:10496
    v_mfma_f32_32x32x16_bf16 v[88:103], v[28:31], v[16:19], v[88:103]
    ds_read_b64_tr_b16 v[52:53], v7 offset:11264
    ds_read_b64_tr_b16 v[54:55], v7 offset:11520
    v_mfma_f32_32x32x16_bf16 v[104:119], v[28:31], v[20:23], v[104:119]
    v_mfma_f32_32x32x16_bf16 v[120:135], v[16:19], v[32:35], v[120:135]
    v_mfma_f32_32x32x16_bf16 v[136:151], v[20:23], v[32:35], v[136:151]
    s_waitcnt lgkmcnt(0)
    v_mfma_f32_32x32x16_bf16 v[56:71], v[44:47], v[36:39], v[56:71]
    s_waitcnt vmcnt(0)
    s_barrier
    ds_read_b128 v[16:19], v8 offset:32768
    ds_read_b64_tr_b16 v[24:25], v7 offset:12288
    ds_read_b64_tr_b16 v[26:27], v7 offset:12544
    v_mfma_f32_32x32x16_bf16 v[72:87], v[44:47], v[40:43], v[72:87]
    ds_read_b128 v[20:23], v8 offset:36864
    ds_read_b64_tr_b16 v[28:29], v7 offset:13312
    ds_read_b64_tr_b16 v[30:31], v7 offset:13568
    v_mfma_f32_32x32x16_bf16 v[88:103], v[48:51], v[36:39], v[88:103]
    ds_read_b64_tr_b16 v[32:33], v7 offset:14336
    ds_read_b64_tr_b16 v[34:35], v7 offset:14592
    v_mfma_f32_32x32x16_bf16 v[104:119], v[48:51], v[40:43], v[104:119]
    v_mfma_f32_32x32x16_bf16 v[120:135], v[36:39], v[52:55], v[120:135]
    v_mfma_f32_32x32x16_bf16 v[136:151], v[40:43], v[52:55], v[136:151]
    s_waitcnt lgkmcnt(0)
    v_mfma_f32_32x32x16_bf16 v[56:71], v[24:27], v[16:19], v[56:71]
    ds_read_b128 v[36:39], v9 offset:32768
    ds_read_b64_tr_b16 v[44:45], v7 offset:15360
    ds_read_b64_tr_b16 v[46:47], v7 offset:15616
    v_mfma_f32_32x32x16_bf16 v[72:87], v[24:27], v[20:23], v[72:87]
    ds_read_b128 v[40:43], v9 offset:36864
    ds_read_b64_tr_b16 v[48:49], v7 offset:16384
    ds_read_b64_tr_b16 v[50:51], v7 offset:16640
    v_mfma_f32_32x32x16_bf16 v[88:103], v[28:31], v[16:19], v[88:103]
    ds_read_b64_tr_b16 v[52:53], v7 offset:17408
    ds_read_b64_tr_b16 v[54:55], v7 offset:17664
    v_mfma_f32_32x32x16_bf16 v[104:119], v[28:31], v[20:23], v[104:119]
    v_mfma_f32_32x32x16_bf16 v[120:135], v[16:19], v[32:35], v[120:135]
    v_mfma_f32_32x32x16_bf16 v[136:151], v[20:23], v[32:35], v[136:151]
    s_waitcnt lgkmcnt(0)
    v_mfma_f32_32x32x16_bf16 v[56:71], v[44:47], v[36:39], v[56:71]
    ds_read_b128 v[16:19], v10 offset:32768
    ds_read_b64_tr_b16 v[24:25], v7 offset:18432
    ds_read_b64_tr_b16 v[26:27], v7 offset:18688
    v_mfma_f32_32x32x16_bf16 v[72:87], v[44:47], v[40:43], v[72:87]
    ds_read_b128 v[20:23], v10 offset:36864
    ds_read_b64_tr_b16 v[28:29], v7 offset:19456
    ds_read_b64_tr_b16 v[30:31], v7 offset:19712
    v_mfma_f32_32x32x16_bf16 v[88:103], v[48:51], v[36:39], v[88:103]
    ds_read_b64_tr_b16 v[32:33], v7 offset:20480
    ds_read_b64_tr_b16 v[34:35], v7 offset:20736
    v_mfma_f32_32x32x16_bf16 v[104:119], v[48:51], v[40:43], v[104:119]
    v_mfma_f32_32x32x16_bf16 v[120:135], v[36:39], v[52:55], v[120:135]
    v_mfma_f32_32x32x16_bf16 v[136:151], v[40:43], v[52:55], v[136:151]
    s_waitcnt lgkmcnt(0)
    v_mfma_f32_32x32x16_bf16 v[56:71], v[24:27], v[16:19], v[56:71]
    ds_read_b128 v[36:39], v11 offset:32768
    ds_read_b64_tr_b16 v[44:45], v7 offset:21504
    ds_read_b64_tr_b16 v[46:47], v7 offset:21760
    v_mfma_f32_32x32x16_bf16 v[72:87], v[24:27], v[20:23], v[72:87]
    ds_read_b128 v[40:43], v11 offset:36864
    ds_read_b64_tr_b16 v[48:49], v7 offset:22528
    ds_read_b64_tr_b16 v[50:51], v7 offset:22784
    v_mfma_f32_32x32x16_bf16 v[88:103], v[28:31], v[16:19], v[88:103]
    ds_read_b64_tr_b16 v[52:53], v7 offset:23552
    ds_read_b64_tr_b16 v[54:55], v7 offset:23808
    v_mfma_f32_32x32x16_bf16 v[104:119], v[28:31], v[20:23], v[104:119]
    v_mfma_f32_32x32x16_bf16 v[120:135], v[16:19], v[32:35], v[120:135]
    v_mfma_f32_32x32x16_bf16 v[136:151], v[20:23], v[32:35], v[136:151]
    s_waitcnt lgkmcnt(0)
    v_mfma_f32_32x32x16_bf16 v[56:71], v[44:47], v[36:39], v[56:71]
    s_barrier
    ds_read_b128 v[16:19], v12 offset:0
    ds_read_b64_tr_b16 v[24:25], v7 offset:24576
    ds_read_b64_tr_b16 v[26:27], v7 offset:24832
    v_mfma_f32_32x32x16_bf16 v[72:87], v[44:47], v[40:43], v[72:87]
    ds_read_b128 v[20:23], v12 offset:4096
    ds_read_b64_tr_b16 v[28:29], v7 offset:25600
    ds_read_b64_tr_b16 v[30:31], v7 offset:25856
    v_mfma_f32_32x32x16_bf16 v[88:103], v[48:51], v[36:39], v[88:103]
    ds_read_b64_tr_b16 v[32:33], v7 offset:26624
    ds_read_b64_tr_b16 v[34:35], v7 offset:26880
    v_mfma_f32_32x32x16_bf16 v[104:119], v[48:51], v[40:43], v[104:119]
    v_mfma_f32_32x32x16_bf16 v[120:135], v[36:39], v[52:55], v[120:135]
    v_mfma_f32_32x32x16_bf16 v[136:151], v[40:43], v[52:55], v[136:151]
    s_waitcnt lgkmcnt(0)
    v_mfma_f32_32x32x16_bf16 v[56:71], v[24:27], v[16:19], v[56:71]
    ds_read_b128 v[36:39], v13 offset:0
    ds_read_b64_tr_b16 v[44:45], v7 offset:27648
    ds_read_b64_tr_b16 v[46:47], v7 offset:27904
    v_mfma_f32_32x32x16_bf16 v[72:87], v[24:27], v[20:23], v[72:87]
    ds_read_b128 v[40:43], v13 offset:4096
    ds_read_b64_tr_b16 v[48:49], v7 offset:28672
    ds_read_b64_tr_b16 v[50:51], v7 offset:28928
    v_mfma_f32_32x32x16_bf16 v[88:103], v[28:31], v[16:19], v[88:103]
    ds_read_b64_tr_b16 v[52:53], v7 offset:29696
    ds_read_b64_tr_b16 v[54:55], v7 offset:29952
    v_mfma_f32_32x32x16_bf16 v[104:119], v[28:31], v[20:23], v[104:119]
    v_mfma_f32_32x32x16_bf16 v[120:135], v[16:19], v[32:35], v[120:135]
    v_mfma_f32_32x32x16_bf16 v[136:151], v[20:23], v[32:35], v[136:151]
    s_waitcnt lgkmcnt(0)
    v_mfma_f32_32x32x16_bf16 v[56:71], v[44:47], v[36:39], v[56:71]
    ds_read_b128 v[16:19], v14 offset:0
    ds_read_b64_tr_b16 v[24:25], v7 offset:30720
    ds_read_b64_tr_b16 v[26:27], v7 offset:30976
    v_mfma_f32_32x32x16_bf16 v[72:87], v[44:47], v[40:43], v[72:87]
    ds_read_b128 v[20:23], v14 offset:4096
    ds_read_b64_tr_b16 v[28:29], v7 offset:31744
    ds_read_b64_tr_b16 v[30:31], v7 offset:32000
    v_mfma_f32_32x32x16_bf16 v[88:103], v[48:51], v[36:39], v[88:103]
    ds_read_b64_tr_b16 v[32:33], v7 offset:32768
    ds_read_b64_tr_b16 v[34:35], v7 offset:33024
    v_mfma_f32_32x32x16_bf16 v[104:119], v[48:51], v[40:43], v[104:119]
    v_mfma_f32_32x32x16_bf16 v[120:135], v[36:39], v[52:55], v[120:135]
    v_mfma_f32_32x32x16_bf16 v[136:151], v[40:43], v[52:55], v[136:151]
    s_waitcnt lgkmcnt(0)
    v_mfma_f32_32x32x16_bf16 v[56:71], v[24:27], v[16:19], v[56:71]
    ds_read_b128 v[36:39], v15 offset:0
    ds_read_b64_tr_b16 v[44:45], v7 offset:33792
    ds_read_b64_tr_b16 v[46:47], v7 offset:34048
    v_mfma_f32_32x32x16_bf16 v[72:87], v[24:27], v[20:23], v[72:87]
    ds_read_b128 v[40:43], v15 offset:4096
    ds_read_b64_tr_b16 v[48:49], v7 offset:34816
    ds_read_b64_tr_b16 v[50:51], v7 offset:35072
    v_mfma_f32_32x32x16_bf16 v[88:103], v[28:31], v[16:19], v[88:103]
    ds_read_b64_tr_b16 v[52:53], v7 offset:35840
    ds_read_b64_tr_b16 v[54:55], v7 offset:36096
    v_mfma_f32_32x32x16_bf16 v[104:119], v[28:31], v[20:23], v[104:119]
    v_mfma_f32_32x32x16_bf16 v[120:135], v[16:19], v[32:35], v[120:135]
    v_mfma_f32_32x32x16_bf16 v[136:151], v[20:23], v[32:35], v[136:151]
    s_waitcnt lgkmcnt(0)
    v_mfma_f32_32x32x16_bf16 v[56:71], v[44:47], v[36:39], v[56:71]
    s_barrier
    ds_read_b128 v[16:19], v8 offset:0
    ds_read_b64_tr_b16 v[24:25], v7 offset:0
    ds_read_b64_tr_b16 v[26:27], v7 offset:256
    v_mfma_f32_32x32x16_bf16 v[72:87], v[44:47], v[40:43], v[72:87]
    ds_read_b128 v[20:23], v8 offset:4096
    ds_read_b64_tr_b16 v[28:29], v7 offset:1024
    ds_read_b64_tr_b16 v[30:31], v7 offset:1280
    v_mfma_f32_32x32x16_bf16 v[88:103], v[48:51], v[36:39], v[88:103]
    ds_read_b64_tr_b16 v[32:33], v7 offset:2048
    ds_read_b64_tr_b16 v[34:35], v7 offset:2304
    v_mfma_f32_32x32x16_bf16 v[104:119], v[48:51], v[40:43], v[104:119]
    v_mfma_f32_32x32x16_bf16 v[120:135], v[36:39], v[52:55], v[120:135]
    v_mfma_f32_32x32x16_bf16 v[136:151], v[40:43], v[52:55], v[136:151]
    s_waitcnt lgkmcnt(0)
    v_mfma_f32_32x32x16_bf16 v[56:71], v[24:27], v[16:19], v[56:71]
    ds_read_b128 v[36:39], v9 offset:0
    ds_read_b64_tr_b16 v[44:45], v7 offset:3072
    ds_read_b64_tr_b16 v[46:47], v7 offset:3328
    v_mfma_f32_32x32x16_bf16 v[72:87], v[24:27], v[20:23], v[72:87]
    ds_read_b128 v[40:43], v9 offset:4096
    ds_read_b64_tr_b16 v[48:49], v7 offset:4096
    ds_read_b64_tr_b16 v[50:51], v7 offset:4352
    v_mfma_f32_32x32x16_bf16 v[88:103], v[28:31], v[16:19], v[88:103]
    ds_read_b64_tr_b16 v[52:53], v7 offset:5120
    ds_read_b64_tr_b16 v[54:55], v7 offset:5376
    v_mfma_f32_32x32x16_bf16 v[104:119], v[28:31], v[20:23], v[104:119]
    v_mfma_f32_32x32x16_bf16 v[120:135], v[16:19], v[32:35], v[120:135]
    v_mfma_f32_32x32x16_bf16 v[136:151], v[20:23], v[32:35], v[136:151]
    s_waitcnt lgkmcnt(0)
    v_mfma_f32_32x32x16_bf16 v[56:71], v[44:47], v[36:39], v[56:71]
    ds_read_b128 v[16:19], v10 offset:0
    ds_read_b64_tr_b16 v[24:25], v7 offset:6144
    ds_read_b64_tr_b16 v[26:27], v7 offset:6400
    v_mfma_f32_32x32x16_bf16 v[72:87], v[44:47], v[40:43], v[72:87]
    ds_read_b128 v[20:23], v10 offset:4096
    ds_read_b64_tr_b16 v[28:29], v7 offset:7168
    ds_read_b64_tr_b16 v[30:31], v7 offset:7424
    v_mfma_f32_32x32x16_bf16 v[88:103], v[48:51], v[36:39], v[88:103]
    ds_read_b64_tr_b16 v[32:33], v7 offset:8192
    ds_read_b64_tr_b16 v[34:35], v7 offset:8448
    v_mfma_f32_32x32x16_bf16 v[104:119], v[48:51], v[40:43], v[104:119]
    v_mfma_f32_32x32x16_bf16 v[120:135], v[36:39], v[52:55], v[120:135]
    v_mfma_f32_32x32x16_bf16 v[136:151], v[40:43], v[52:55], v[136:151]
    s_waitcnt lgkmcnt(0)
    v_mfma_f32_32x32x16_bf16 v[56:71], v[24:27], v[16:19], v[56:71]
    ds_read_b128 v[36:39], v11 offset:0
    ds_read_b64_tr_b16 v[44:45], v7 offset:9216
    ds_read_b64_tr_b16 v[46:47], v7 offset:9472
    v_mfma_f32_32x32x16_bf16 v[72:87], v[24:27], v[20:23], v[72:87]
    ds_read_b128 v[40:43], v11 offset:4096
    ds_read_b64_tr_b16 v[48:49], v7 offset:10240
    ds_read_b64_tr_b16 v[50:51], v7 offset:10496
    v_mfma_f32_32x32x16_bf16 v[88:103], v[28:31], v[16:19], v[88:103]
    ds_read_b64_tr_b16 v[52:53], v7 offset:11264
    ds_read_b64_tr_b16 v[54:55], v7 offset:11520
    v_mfma_f32_32x32x16_bf16 v[104:119], v[28:31], v[20:23], v[104:119]
    v_mfma_f32_32x32x16_bf16 v[120:135], v[16:19], v[32:35], v[120:135]
    v_mfma_f32_32x32x16_bf16 v[136:151], v[20:23], v[32:35], v[136:151]
    s_waitcnt lgkmcnt(0)
    v_mfma_f32_32x32x16_bf16 v[56:71], v[44:47], v[36:39], v[56:71]
    s_barrier
    ds_read_b128 v[16:19], v8 offset:32768
    ds_read_b64_tr_b16 v[24:25], v7 offset:12288
    ds_read_b64_tr_b16 v[26:27], v7 offset:12544
    v_mfma_f32_32x32x16_bf16 v[72:87], v[44:47], v[40:43], v[72:87]
    ds_read_b128 v[20:23], v8 offset:36864
    ds_read_b64_tr_b16 v[28:29], v7 offset:13312
    ds_read_b64_tr_b16 v[30:31], v7 offset:13568
    v_mfma_f32_32x32x16_bf16 v[88:103], v[48:51], v[36:39], v[88:103]
    ds_read_b64_tr_b16 v[32:33], v7 offset:14336
    ds_read_b64_tr_b16 v[34:35], v7 offset:14592
    v_mfma_f32_32x32x16_bf16 v[104:119], v[48:51], v[40:43], v[104:119]
    v_mfma_f32_32x32x16_bf16 v[120:135], v[36:39], v[52:55], v[120:135]
    v_mfma_f32_32x32x16_bf16 v[136:151], v[40:43], v[52:55], v[136:151]
    s_waitcnt lgkmcnt(0)
    v_mfma_f32_32x32x16_bf16 v[56:71], v[24:27], v[16:19], v[56:71]
    ds_read_b128 v[36:39], v9 offset:32768
    ds_read_b64_tr_b16 v[44:45], v7 offset:15360
    ds_read_b64_tr_b16 v[46:47], v7 offset:15616
    v_mfma_f32_32x32x16_bf16 v[72:87], v[24:27], v[20:23], v[72:87]
    ds_read_b128 v[40:43], v9 offset:36864
    ds_read_b64_tr_b16 v[48:49], v7 offset:16384
    ds_read_b64_tr_b16 v[50:51], v7 offset:16640
    v_mfma_f32_32x32x16_bf16 v[88:103], v[28:31], v[16:19], v[88:103]
    ds_read_b64_tr_b16 v[52:53], v7 offset:17408
    ds_read_b64_tr_b16 v[54:55], v7 offset:17664
    v_mfma_f32_32x32x16_bf16 v[104:119], v[28:31], v[20:23], v[104:119]
    v_mfma_f32_32x32x16_bf16 v[120:135], v[16:19], v[32:35], v[120:135]
    v_mfma_f32_32x32x16_bf16 v[136:151], v[20:23], v[32:35], v[136:151]
    s_waitcnt lgkmcnt(0)
    v_mfma_f32_32x32x16_bf16 v[56:71], v[44:47], v[36:39], v[56:71]
    ds_read_b128 v[16:19], v10 offset:32768
    ds_read_b64_tr_b16 v[24:25], v7 offset:18432
    ds_read_b64_tr_b16 v[26:27], v7 offset:18688
    v_mfma_f32_32x32x16_bf16 v[72:87], v[44:47], v[40:43], v[72:87]
    ds_read_b128 v[20:23], v10 offset:36864
    ds_read_b64_tr_b16 v[28:29], v7 offset:19456
    ds_read_b64_tr_b16 v[30:31], v7 offset:19712
    v_mfma_f32_32x32x16_bf16 v[88:103], v[48:51], v[36:39], v[88:103]
    ds_read_b64_tr_b16 v[32:33], v7 offset:20480
    ds_read_b64_tr_b16 v[34:35], v7 offset:20736
    v_mfma_f32_32x32x16_bf16 v[104:119], v[48:51], v[40:43], v[104:119]
    v_mfma_f32_32x32x16_bf16 v[120:135], v[36:39], v[52:55], v[120:135]
    v_mfma_f32_32x32x16_bf16 v[136:151], v[40:43], v[52:55], v[136:151]
    s_waitcnt lgkmcnt(0)
    v_mfma_f32_32x32x16_bf16 v[56:71], v[24:27], v[16:19], v[56:71]
    ds_read_b128 v[36:39], v11 offset:32768
    ds_read_b64_tr_b16 v[44:45], v7 offset:21504
    ds_read_b64_tr_b16 v[46:47], v7 offset:21760
    v_mfma_f32_32x32x16_bf16 v[72:87], v[24:27], v[20:23], v[72:87]
    ds_read_b128 v[40:43], v11 offset:36864
    ds_read_b64_tr_b16 v[48:49], v7 offset:22528
    ds_read_b64_tr_b16 v[50:51], v7 offset:22784
    v_mfma_f32_32x32x16_bf16 v[88:103], v[28:31], v[16:19], v[88:103]
    ds_read_b64_tr_b16 v[52:53], v7 offset:23552
    ds_read_b64_tr_b16 v[54:55], v7 offset:23808
    v_mfma_f32_32x32x16_bf16 v[104:119], v[28:31], v[20:23], v[104:119]
    v_mfma_f32_32x32x16_bf16 v[120:135], v[16:19], v[32:35], v[120:135]
    v_mfma_f32_32x32x16_bf16 v[136:151], v[20:23], v[32:35], v[136:151]
    s_waitcnt lgkmcnt(0)
    v_mfma_f32_32x32x16_bf16 v[56:71], v[44:47], v[36:39], v[56:71]
    s_barrier
    ds_read_b128 v[16:19], v12 offset:0
    ds_read_b64_tr_b16 v[24:25], v7 offset:24576
    ds_read_b64_tr_b16 v[26:27], v7 offset:24832
    v_mfma_f32_32x32x16_bf16 v[72:87], v[44:47], v[40:43], v[72:87]
    ds_read_b128 v[20:23], v12 offset:4096
    ds_read_b64_tr_b16 v[28:29], v7 offset:25600
    ds_read_b64_tr_b16 v[30:31], v7 offset:25856
    v_mfma_f32_32x32x16_bf16 v[88:103], v[48:51], v[36:39], v[88:103]
    ds_read_b64_tr_b16 v[32:33], v7 offset:26624
    ds_read_b64_tr_b16 v[34:35], v7 offset:26880
    v_mfma_f32_32x32x16_bf16 v[104:119], v[48:51], v[40:43], v[104:119]
    v_mfma_f32_32x32x16_bf16 v[120:135], v[36:39], v[52:55], v[120:135]
    v_mfma_f32_32x32x16_bf16 v[136:151], v[40:43], v[52:55], v[136:151]
    s_waitcnt lgkmcnt(0)
    v_mfma_f32_32x32x16_bf16 v[56:71], v[24:27], v[16:19], v[56:71]
    ds_read_b128 v[36:39], v13 offset:0
    ds_read_b64_tr_b16 v[44:45], v7 offset:27648
    ds_read_b64_tr_b16 v[46:47], v7 offset:27904
    v_mfma_f32_32x32x16_bf16 v[72:87], v[24:27], v[20:23], v[72:87]
    ds_read_b128 v[40:43], v13 offset:4096
    ds_read_b64_tr_b16 v[48:49], v7 offset:28672
    ds_read_b64_tr_b16 v[50:51], v7 offset:28928
    v_mfma_f32_32x32x16_bf16 v[88:103], v[28:31], v[16:19], v[88:103]
    ds_read_b64_tr_b16 v[52:53], v7 offset:29696
    ds_read_b64_tr_b16 v[54:55], v7 offset:29952
    v_mfma_f32_32x32x16_bf16 v[104:119], v[28:31], v[20:23], v[104:119]
    v_mfma_f32_32x32x16_bf16 v[120:135], v[16:19], v[32:35], v[120:135]
    v_mfma_f32_32x32x16_bf16 v[136:151], v[20:23], v[32:35], v[136:151]
    s_waitcnt lgkmcnt(0)
    v_mfma_f32_32x32x16_bf16 v[56:71], v[44:47], v[36:39], v[56:71]
    ds_read_b128 v[16:19], v14 offset:0
    ds_read_b64_tr_b16 v[24:25], v7 offset:30720
    ds_read_b64_tr_b16 v[26:27], v7 offset:30976
    v_mfma_f32_32x32x16_bf16 v[72:87], v[44:47], v[40:43], v[72:87]
    ds_read_b128 v[20:23], v14 offset:4096
    ds_read_b64_tr_b16 v[28:29], v7 offset:31744
    ds_read_b64_tr_b16 v[30:31], v7 offset:32000
    v_mfma_f32_32x32x16_bf16 v[88:103], v[48:51], v[36:39], v[88:103]
    ds_read_b64_tr_b16 v[32:33], v7 offset:32768
    ds_read_b64_tr_b16 v[34:35], v7 offset:33024
    v_mfma_f32_32x32x16_bf16 v[104:119], v[48:51], v[40:43], v[104:119]
    v_mfma_f32_32x32x16_bf16 v[120:135], v[36:39], v[52:55], v[120:135]
    v_mfma_f32_32x32x16_bf16 v[136:151], v[40:43], v[52:55], v[136:151]
    s_waitcnt lgkmcnt(0)
    v_mfma_f32_32x32x16_bf16 v[56:71], v[24:27], v[16:19], v[56:71]
    ds_read_b128 v[36:39], v15 offset:0
    ds_read_b64_tr_b16 v[44:45], v7 offset:33792
    ds_read_b64_tr_b16 v[46:47], v7 offset:34048
    v_mfma_f32_32x32x16_bf16 v[72:87], v[24:27], v[20:23], v[72:87]
    ds_read_b128 v[40:43], v15 offset:4096
    ds_read_b64_tr_b16 v[48:49], v7 offset:34816
    ds_read_b64_tr_b16 v[50:51], v7 offset:35072
    v_mfma_f32_32x32x16_bf16 v[88:103], v[28:31], v[16:19], v[88:103]
    ds_read_b64_tr_b16 v[52:53], v7 offset:35840
    ds_read_b64_tr_b16 v[54:55], v7 offset:36096
    v_mfma_f32_32x32x16_bf16 v[104:119], v[28:31], v[20:23], v[104:119]
    v_mfma_f32_32x32x16_bf16 v[120:135], v[16:19], v[32:35], v[120:135]
    v_mfma_f32_32x32x16_bf16 v[136:151], v[20:23], v[32:35], v[136:151]
    s_waitcnt lgkmcnt(0)
    v_mfma_f32_32x32x16_bf16 v[56:71], v[44:47], v[36:39], v[56:71]
    s_barrier
    ds_read_b128 v[16:19], v8 offset:0
    ds_read_b64_tr_b16 v[24:25], v7 offset:0
    ds_read_b64_tr_b16 v[26:27], v7 offset:256
    v_mfma_f32_32x32x16_bf16 v[72:87], v[44:47], v[40:43], v[72:87]
    ds_read_b128 v[20:23], v8 offset:4096
    ds_read_b64_tr_b16 v[28:29], v7 offset:1024
    ds_read_b64_tr_b16 v[30:31], v7 offset:1280
    v_mfma_f32_32x32x16_bf16 v[88:103], v[48:51], v[36:39], v[88:103]
    ds_read_b64_tr_b16 v[32:33], v7 offset:2048
    ds_read_b64_tr_b16 v[34:35], v7 offset:2304
    v_mfma_f32_32x32x16_bf16 v[104:119], v[48:51], v[40:43], v[104:119]
    v_mfma_f32_32x32x16_bf16 v[120:135], v[36:39], v[52:55], v[120:135]
    v_mfma_f32_32x32x16_bf16 v[136:151], v[40:43], v[52:55], v[136:151]
    s_waitcnt lgkmcnt(0)
    v_mfma_f32_32x32x16_bf16 v[56:71], v[24:27], v[16:19], v[56:71]
    ds_read_b128 v[36:39], v9 offset:0
    ds_read_b64_tr_b16 v[44:45], v7 offset:3072
    ds_read_b64_tr_b16 v[46:47], v7 offset:3328
    v_mfma_f32_32x32x16_bf16 v[72:87], v[24:27], v[20:23], v[72:87]
    ds_read_b128 v[40:43], v9 offset:4096
    ds_read_b64_tr_b16 v[48:49], v7 offset:4096
    ds_read_b64_tr_b16 v[50:51], v7 offset:4352
    v_mfma_f32_32x32x16_bf16 v[88:103], v[28:31], v[16:19], v[88:103]
    ds_read_b64_tr_b16 v[52:53], v7 offset:5120
    ds_read_b64_tr_b16 v[54:55], v7 offset:5376
    v_mfma_f32_32x32x16_bf16 v[104:119], v[28:31], v[20:23], v[104:119]
    v_mfma_f32_32x32x16_bf16 v[120:135], v[16:19], v[32:35], v[120:135]
    v_mfma_f32_32x32x16_bf16 v[136:151], v[20:23], v[32:35], v[136:151]
    s_waitcnt lgkmcnt(0)
    v_mfma_f32_32x32x16_bf16 v[56:71], v[44:47], v[36:39], v[56:71]
    ds_read_b128 v[16:19], v10 offset:0
    ds_read_b64_tr_b16 v[24:25], v7 offset:6144
    ds_read_b64_tr_b16 v[26:27], v7 offset:6400
    v_mfma_f32_32x32x16_bf16 v[72:87], v[44:47], v[40:43], v[72:87]
    ds_read_b128 v[20:23], v10 offset:4096
    ds_read_b64_tr_b16 v[28:29], v7 offset:7168
    ds_read_b64_tr_b16 v[30:31], v7 offset:7424
    v_mfma_f32_32x32x16_bf16 v[88:103], v[48:51], v[36:39], v[88:103]
    ds_read_b64_tr_b16 v[32:33], v7 offset:8192
    ds_read_b64_tr_b16 v[34:35], v7 offset:8448
    v_mfma_f32_32x32x16_bf16 v[104:119], v[48:51], v[40:43], v[104:119]
    v_mfma_f32_32x32x16_bf16 v[120:135], v[36:39], v[52:55], v[120:135]
    v_mfma_f32_32x32x16_bf16 v[136:151], v[40:43], v[52:55], v[136:151]
    s_waitcnt lgkmcnt(0)
    v_mfma_f32_32x32x16_bf16 v[56:71], v[24:27], v[16:19], v[56:71]
    ds_read_b128 v[36:39], v11 offset:0
    ds_read_b64_tr_b16 v[44:45], v7 offset:9216
    ds_read_b64_tr_b16 v[46:47], v7 offset:9472
    v_mfma_f32_32x32x16_bf16 v[72:87], v[24:27], v[20:23], v[72:87]
    ds_read_b128 v[40:43], v11 offset:4096
    ds_read_b64_tr_b16 v[48:49], v7 offset:10240
    ds_read_b64_tr_b16 v[50:51], v7 offset:10496
    v_mfma_f32_32x32x16_bf16 v[88:103], v[28:31], v[16:19], v[88:103]
    ds_read_b64_tr_b16 v[52:53], v7 offset:11264
    ds_read_b64_tr_b16 v[54:55], v7 offset:11520
    v_mfma_f32_32x32x16_bf16 v[104:119], v[28:31], v[20:23], v[104:119]
    v_mfma_f32_32x32x16_bf16 v[120:135], v[16:19], v[32:35], v[120:135]
    v_mfma_f32_32x32x16_bf16 v[136:151], v[20:23], v[32:35], v[136:151]
    s_waitcnt lgkmcnt(0)
    v_mfma_f32_32x32x16_bf16 v[56:71], v[44:47], v[36:39], v[56:71]
    s_barrier
    ds_read_b128 v[16:19], v8 offset:32768
    ds_read_b64_tr_b16 v[24:25], v7 offset:12288
    ds_read_b64_tr_b16 v[26:27], v7 offset:12544
    v_mfma_f32_32x32x16_bf16 v[72:87], v[44:47], v[40:43], v[72:87]
    ds_read_b128 v[20:23], v8 offset:36864
    ds_read_b64_tr_b16 v[28:29], v7 offset:13312
    ds_read_b64_tr_b16 v[30:31], v7 offset:13568
    v_mfma_f32_32x32x16_bf16 v[88:103], v[48:51], v[36:39], v[88:103]
    ds_read_b64_tr_b16 v[32:33], v7 offset:14336
    ds_read_b64_tr_b16 v[34:35], v7 offset:14592
    v_mfma_f32_32x32x16_bf16 v[104:119], v[48:51], v[40:43], v[104:119]
    v_mfma_f32_32x32x16_bf16 v[120:135], v[36:39], v[52:55], v[120:135]
    v_mfma_f32_32x32x16_bf16 v[136:151], v[40:43], v[52:55], v[136:151]
    s_waitcnt lgkmcnt(0)
    v_mfma_f32_32x32x16_bf16 v[56:71], v[24:27], v[16:19], v[56:71]
    ds_read_b128 v[36:39], v9 offset:32768
    ds_read_b64_tr_b16 v[44:45], v7 offset:15360
    ds_read_b64_tr_b16 v[46:47], v7 offset:15616
    v_mfma_f32_32x32x16_bf16 v[72:87], v[24:27], v[20:23], v[72:87]
    ds_read_b128 v[40:43], v9 offset:36864
    ds_read_b64_tr_b16 v[48:49], v7 offset:16384
    ds_read_b64_tr_b16 v[50:51], v7 offset:16640
    v_mfma_f32_32x32x16_bf16 v[88:103], v[28:31], v[16:19], v[88:103]
    ds_read_b64_tr_b16 v[52:53], v7 offset:17408
    ds_read_b64_tr_b16 v[54:55], v7 offset:17664
    v_mfma_f32_32x32x16_bf16 v[104:119], v[28:31], v[20:23], v[104:119]
    v_mfma_f32_32x32x16_bf16 v[120:135], v[16:19], v[32:35], v[120:135]
    v_mfma_f32_32x32x16_bf16 v[136:151], v[20:23], v[32:35], v[136:151]
    s_waitcnt lgkmcnt(0)
    v_mfma_f32_32x32x16_bf16 v[56:71], v[44:47], v[36:39], v[56:71]
    ds_read_b128 v[16:19], v10 offset:32768
    ds_read_b64_tr_b16 v[24:25], v7 offset:18432
    ds_read_b64_tr_b16 v[26:27], v7 offset:18688
    v_mfma_f32_32x32x16_bf16 v[72:87], v[44:47], v[40:43], v[72:87]
    ds_read_b128 v[20:23], v10 offset:36864
    ds_read_b64_tr_b16 v[28:29], v7 offset:19456
    ds_read_b64_tr_b16 v[30:31], v7 offset:19712
    v_mfma_f32_32x32x16_bf16 v[88:103], v[48:51], v[36:39], v[88:103]
    ds_read_b64_tr_b16 v[32:33], v7 offset:20480
    ds_read_b64_tr_b16 v[34:35], v7 offset:20736
    v_mfma_f32_32x32x16_bf16 v[104:119], v[48:51], v[40:43], v[104:119]
    v_mfma_f32_32x32x16_bf16 v[120:135], v[36:39], v[52:55], v[120:135]
    v_mfma_f32_32x32x16_bf16 v[136:151], v[40:43], v[52:55], v[136:151]
    s_waitcnt lgkmcnt(0)
    v_mfma_f32_32x32x16_bf16 v[56:71], v[24:27], v[16:19], v[56:71]
    ds_read_b128 v[36:39], v11 offset:32768
    ds_read_b64_tr_b16 v[44:45], v7 offset:21504
    ds_read_b64_tr_b16 v[46:47], v7 offset:21760
    v_mfma_f32_32x32x16_bf16 v[72:87], v[24:27], v[20:23], v[72:87]
    ds_read_b128 v[40:43], v11 offset:36864
    ds_read_b64_tr_b16 v[48:49], v7 offset:22528
    ds_read_b64_tr_b16 v[50:51], v7 offset:22784
    v_mfma_f32_32x32x16_bf16 v[88:103], v[28:31], v[16:19], v[88:103]
    ds_read_b64_tr_b16 v[52:53], v7 offset:23552
    ds_read_b64_tr_b16 v[54:55], v7 offset:23808
    v_mfma_f32_32x32x16_bf16 v[104:119], v[28:31], v[20:23], v[104:119]
    v_mfma_f32_32x32x16_bf16 v[120:135], v[16:19], v[32:35], v[120:135]
    v_mfma_f32_32x32x16_bf16 v[136:151], v[20:23], v[32:35], v[136:151]
    s_waitcnt lgkmcnt(0)
    v_mfma_f32_32x32x16_bf16 v[56:71], v[44:47], v[36:39], v[56:71]
    v_mfma_f32_32x32x16_bf16 v[72:87], v[44:47], v[40:43], v[72:87]
    v_mfma_f32_32x32x16_bf16 v[88:103], v[48:51], v[36:39], v[88:103]
    v_mfma_f32_32x32x16_bf16 v[104:119], v[48:51], v[40:43], v[104:119]
    v_mfma_f32_32x32x16_bf16 v[120:135], v[36:39], v[52:55], v[120:135]
    v_mfma_f32_32x32x16_bf16 v[136:151], v[40:43], v[52:55], v[136:151]
    v_pk_mul_f32 v[56:57], v[56:57], s[96:97]
    v_pk_mul_f32 v[58:59], v[58:59], s[96:97]
    v_pk_mul_f32 v[60:61], v[60:61], s[96:97]
    v_pk_mul_f32 v[62:63], v[62:63], s[96:97]
    v_pk_mul_f32 v[64:65], v[64:65], s[96:97]
    v_pk_mul_f32 v[66:67], v[66:67], s[96:97]
    v_pk_mul_f32 v[68:69], v[68:69], s[96:97]
    v_pk_mul_f32 v[70:71], v[70:71], s[96:97]
    v_pk_mul_f32 v[72:73], v[72:73], s[96:97]
    v_pk_mul_f32 v[74:75], v[74:75], s[96:97]
    v_pk_mul_f32 v[76:77], v[76:77], s[96:97]
    v_pk_mul_f32 v[78:79], v[78:79], s[96:97]
    v_pk_mul_f32 v[80:81], v[80:81], s[96:97]
    v_pk_mul_f32 v[82:83], v[82:83], s[96:97]
    v_pk_mul_f32 v[84:85], v[84:85], s[96:97]
    v_pk_mul_f32 v[86:87], v[86:87], s[96:97]
    v_cvt_pk_bf16_f32 v208, v88, v89
    v_cvt_pk_bf16_f32 v209, v90, v91
    v_cvt_pk_bf16_f32 v210, v92, v93
    v_cvt_pk_bf16_f32 v211, v94, v95
    ds_write_b128 v152, v[208:211] offset:0
    v_cvt_pk_bf16_f32 v212, v96, v97
    v_cvt_pk_bf16_f32 v213, v98, v99
    v_cvt_pk_bf16_f32 v214, v100, v101
    v_cvt_pk_bf16_f32 v215, v102, v103
    ds_write_b128 v152, v[212:215] offset:16384
    v_cvt_pk_bf16_f32 v216, v104, v105
    v_cvt_pk_bf16_f32 v217, v106, v107
    v_cvt_pk_bf16_f32 v218, v108, v109
    v_cvt_pk_bf16_f32 v219, v110, v111
    ds_write_b128 v152, v[216:219] offset:1024
    v_cvt_pk_bf16_f32 v220, v112, v113
    v_cvt_pk_bf16_f32 v221, v114, v115
    v_cvt_pk_bf16_f32 v222, v116, v117
    v_cvt_pk_bf16_f32 v223, v118, v119
    ds_write_b128 v152, v[220:223] offset:17408
    v_cvt_pk_bf16_f32 v224, v120, v121
    v_cvt_pk_bf16_f32 v225, v122, v123
    v_cvt_pk_bf16_f32 v226, v124, v125
    v_cvt_pk_bf16_f32 v227, v126, v127
    ds_write_b128 v153, v[224:227] offset:0
    v_cvt_pk_bf16_f32 v228, v128, v129
    v_cvt_pk_bf16_f32 v229, v130, v131
    v_cvt_pk_bf16_f32 v230, v132, v133
    v_cvt_pk_bf16_f32 v231, v134, v135
    ds_write_b128 v153, v[228:231] offset:512
    v_cvt_pk_bf16_f32 v232, v136, v137
    v_cvt_pk_bf16_f32 v233, v138, v139
    v_cvt_pk_bf16_f32 v234, v140, v141
    v_cvt_pk_bf16_f32 v235, v142, v143
    ds_write_b128 v153, v[232:235] offset:1024
    v_cvt_pk_bf16_f32 v236, v144, v145
    v_cvt_pk_bf16_f32 v237, v146, v147
    v_cvt_pk_bf16_f32 v238, v148, v149
    v_cvt_pk_bf16_f32 v239, v150, v151
    ds_write_b128 v153, v[236:239] offset:1536
    v_cvt_pk_bf16_f32 v240, v64, v65
    v_cvt_pk_bf16_f32 v241, v66, v67
    v_cvt_pk_bf16_f32 v242, v68, v69
    v_cvt_pk_bf16_f32 v243, v70, v71
    ds_write_b128 v154, v[240:243] offset:0
    v_cvt_pk_bf16_f32 v244, v80, v81
    v_cvt_pk_bf16_f32 v245, v82, v83
    v_cvt_pk_bf16_f32 v246, v84, v85
    v_cvt_pk_bf16_f32 v247, v86, v87
    ds_write_b128 v154, v[244:247] offset:1024
    v_cvt_pk_bf16_f32 v200, v56, v57
    v_cvt_pk_bf16_f32 v201, v58, v59
    v_cvt_pk_bf16_f32 v202, v60, v61
    v_cvt_pk_bf16_f32 v203, v62, v63
    v_cvt_pk_bf16_f32 v204, v72, v73
    v_cvt_pk_bf16_f32 v205, v74, v75
    v_cvt_pk_bf16_f32 v206, v76, v77
    v_cvt_pk_bf16_f32 v207, v78, v79
    s_waitcnt lgkmcnt(0)
    s_barrier
    buffer_store_dwordx4 v[208:211], v152, s[32:35], s16 offen offset:0 sc1
    buffer_store_dwordx4 v[212:215], v152, s[32:35], s17 offen offset:0 sc1
    buffer_store_dwordx4 v[216:219], v152, s[32:35], s16 offen offset:1024 sc1
    buffer_store_dwordx4 v[220:223], v152, s[32:35], s17 offen offset:1024 sc1
    buffer_store_dwordx4 v[224:227], v153, s[32:35], s16 offen offset:0 sc1
    buffer_store_dwordx4 v[228:231], v153, s[32:35], s16 offen offset:512 sc1
    buffer_store_dwordx4 v[232:235], v153, s[32:35], s16 offen offset:1024 sc1
    buffer_store_dwordx4 v[236:239], v153, s[32:35], s16 offen offset:1536 sc1
    s_branch gated_mix__softmax_full_mha__softmax_full_mha__prompt_kernel_attn
gated_mix__softmax_full_mha__softmax_full_mha__prompt_kernel_loader:
    s_cmp_lg_u32 s2, 0
    s_cbranch_scc1 gated_mix__softmax_full_mha__softmax_full_mha__prompt_kernel_nozero
    s_cmp_lg_u32 s3, 7
    s_cbranch_scc1 gated_mix__softmax_full_mha__softmax_full_mha__prompt_kernel_nozero
    v_lshlrev_b32 v16, 8, v0
    v_mov_b32 v17, 0
    s_mov_b32 s59, 13762560
    buffer_store_dword v17, v16, s[32:35], s59 offen sc1

    s_mov_b32 s59, 13778944
    buffer_store_dword v17, v16, s[32:35], s59 offen sc1
gated_mix__softmax_full_mha__softmax_full_mha__prompt_kernel_nozero:
    s_bfe_u32 s59, s54, 0x30000
    s_lshl_b32 s60, s59, 7
    s_add_u32 s60, s60, s55
    s_mul_i32 s61, s59, 196608

    s_add_u32 m0, s57, 0
    s_add_u32 s61, s61, s56
    buffer_load_dwordx4 v2, s[24:27], s60 offen offset:0 lds
    buffer_load_dwordx4 v3, s[24:27], s60 offen offset:1024 lds
    buffer_load_dwordx4 v4, s[24:27], s60 offen offset:2048 lds
    buffer_load_dwordx4 v5, s[24:27], s60 offen offset:3072 lds
    s_add_u32 m0, s58, 0
    s_nop 0
    buffer_load_dwordx4 v6, s[28:31], s61 offen offset:2048 lds
    s_cmp_ge_u32 s2, 128
    s_cselect_b32 s36, s14, s8
    s_cselect_b32 s37, s15, s9
    s_mov_b32 s38, 524288
    s_mov_b32 s39, 0x20000

    s_mov_b32 s40, s18
    s_mov_b32 s41, s19
    s_mov_b32 s42, 2097152
    s_mov_b32 s43, 0x20000
    s_mov_b32 s44, s16
    s_mov_b32 s45, s17
    s_mov_b32 s46, 1024
    s_mov_b32 s47, 0x20000
    s_mov_b32 s48, s20
    s_mov_b32 s49, s21
    s_mov_b32 s50, 256
    s_mov_b32 s51, 0x20000
    s_lshl_b32 s59, s52, 18
    s_lshl_b32 s60, s3, 12
    s_add_u32 s4, s59, s60
    s_add_u32 s6, s60, 32768
    s_lshl_b32 s61, s53, 15
    s_add_u32 s16, s59, s61
    s_add_u32 s17, s16, 16384
    s_and_b32 s5, s61, 0
    s_cmp_eq_u32 s5, s61
    s_cselect_b32 s62, 32768, 0
    s_add_u32 s5, s5, s62
    s_mov_b32 s7, 32768
    s_lshl_b32 s9, s52, 8
    s_add_u32 s9, s9, 13762560
    s_lshr_b32 s60, s3, 2
    s_and_b32 s12, s2, 7
    s_lshl_b32 s12, s12, 8
    s_add_u32 s12, s12, 13770752
    s_lshl_b32 s61, s60, 5
    s_add_u32 s61, s61, s52
    s_lshl_b32 s10, s61, 10
    s_lshl_b32 s61, s53, 2
    s_and_b32 s62, s3, 3
    s_add_u32 s61, s61, s62
    s_lshl_b32 s62, s61, 17
    s_add_u32 s10, s10, s62
    s_add_u32 s10, s10, 8388608
    s_add_u32 s11, s10, 65536
    s_lshr_b32 s62, s52, 3
    s_lshl_b32 s62, s62, 5
    s_add_u32 s61, s61, s62
    s_lshl_b32 s20, s61, 10
    s_add_u32 s20, s20, 13631488
    s_and_b32 s61, s2, 7
    s_lshl_b32 s61, s61, 2
    s_lshr_b32 s62, s2, 6
    s_add_u32 s14, s61, s62
    s_bfe_u32 s15, s2, 0x30003
    s_lshr_b32 s61, s3, 1
    s_lshl_b32 s13, s15, 17
    s_lshl_b32 s62, s61, 15
    s_add_u32 s13, s13, s62
    s_add_u32 s13, s13, 12582912
    s_lshl_b32 s21, s14, 17
    s_lshl_b32 s62, s61, 14
    s_add_u32 s21, s21, s62
    s_and_b32 s62, s3, 1
    s_lshl_b32 s63, s62, 16
    s_add_u32 s21, s21, s63
    s_add_u32 s21, s21, 8388608
    s_lshl_b32 s22, s14, 16
    s_lshl_b32 s63, s62, 15
    s_add_u32 s22, s22, s63
    s_lshl_b32 s63, s15, 7
    s_add_u32 s22, s22, s63
    s_and_b32 s63, s61, 1
    s_lshl_b32 s63, s63, 14
    s_add_u32 s22, s22, s63
    s_mov_b32 s18, 0
    s_lshl_b32 s60, s60, 14
    v_add_u32 v155, s60, v1
    v_and_b32 v16, 15, v0
    v_lshlrev_b32 v16, 4, v16
    v_lshrrev_b32 v17, 5, v0
    v_lshl_or_b32 v16, v17, 8, v16
    v_bfe_u32 v17, v0, 4, 1
    v_xor_b32 v157, 1, v17
    s_add_u32 s60, s60, 8192
    v_mov_b32 v18, s60
    v_mov_b32 v19, 135168
    v_cmp_eq_u32 vcc, 0, v17
    v_mov_b32 v158, 0xdddddddd
    v_mov_b32 v161, 1
    v_cndmask_b32 v18, v19, v18, vcc
    v_add_u32 v156, v16, v18
    v_lshl_add_u32 v153, v17, 14, v16
    v_and_b32 v18, 0xb, v0
    v_cmp_eq_u32 vcc, 0, v18
    v_mov_b32 v19, 0x3f803f80
    s_lshl_b32 s60, s3, 10
    s_add_u32 s60, s60, 135168
    v_cndmask_b32 v20, 0, v19, vcc
    v_cndmask_b32 v21, 0, v19, vcc
    v_cndmask_b32 v22, 0, v19, vcc
    v_cndmask_b32 v23, 0, v19, vcc
    v_add_u32 v18, s60, v1
    ds_write_b128 v18, v[20:23]
    v_bfe_u32 v16, v0, 3, 2
    v_and_b32 v18, 7, v0
    v_lshlrev_b32 v18, 2, v18
    v_lshl_add_u32 v164, v16, 7, v18
    v_mov_b32 v159, v155
    v_mov_b32 v160, v156
    v_mov_b32 v165, 155648
    v_mov_b32 v16, 0
    v_mov_b32 v17, 0
    ds_write_b64 v165, v[16:17]

    v_mov_b32 v167, 0
    s_add_u32 s60, s2, 1
    s_and_b32 s60, s60, 3
    s_lshl_b32 s60, s60, 12
    s_add_u32 s98, s21, s60

    s_add_u32 s60, s2, 2
    s_and_b32 s60, s60, 3
    s_lshl_b32 s60, s60, 12
    s_add_u32 s99, s21, s60

    s_add_u32 s60, s2, 3
    s_and_b32 s60, s60, 3
    s_lshl_b32 s60, s60, 12
    s_add_u32 s100, s21, s60

    s_add_u32 s60, s2, 4
    s_and_b32 s60, s60, 3
    s_lshl_b32 s60, s60, 12
    s_add_u32 s101, s21, s60

    s_sub_u32 s60, s2, s15
    s_add_u32 s60, s60, 1
    s_and_b32 s60, s60, 3
    s_lshl_b32 s14, s60, 13

    v_mov_b32 v168, 0
    v_mov_b32 v169, 0
    v_mov_b32 v170, 0
    v_mov_b32 v171, 0
    v_mov_b32 v172, 0
    v_mov_b32 v173, 0
    v_mov_b32 v174, 0
    v_mov_b32 v175, 0
    v_mov_b32 v176, 0
    v_mov_b32 v177, 0
    v_mov_b32 v178, 0
    v_mov_b32 v179, 0
    v_mov_b32 v180, 0
    v_mov_b32 v181, 0
    v_mov_b32 v182, 0
    v_mov_b32 v183, 0
    v_mov_b32 v184, 0
    v_mov_b32 v185, 0
    v_mov_b32 v186, 0
    v_mov_b32 v187, 0
    v_mov_b32 v188, 0
    v_mov_b32 v189, 0
    v_mov_b32 v190, 0
    v_mov_b32 v191, 0
    v_mov_b32 v192, 0
    v_mov_b32 v193, 0
    v_mov_b32 v194, 0
    v_mov_b32 v195, 0
    v_mov_b32 v196, 0
    v_mov_b32 v197, 0
    v_mov_b32 v198, 0
    v_mov_b32 v199, 0
    s_and_b32 s59, s3, 3
    s_lshl_b32 s60, s59, 6
    s_and_b32 s61, s52, 7
    s_lshl_b32 s61, s61, 3
    s_add_u32 s60, s60, s61
    v_lshrrev_b32 v16, 3, v0
    v_add_u32 v16, s60, v16
    v_bfe_u32 v17, v16, 1, 3
    v_and_b32 v18, 7, v0
    v_xor_b32 v17, v17, v18
    v_lshlrev_b32 v17, 4, v17
    v_lshl_add_u32 v7, v16, 7, v17
    v_add_u32 v9, 0x10000, v7
    v_lshlrev_b32 v10, 4, v18
    v_mov_b32 v8, 0
    s_lshl_b32 s59, s59, 11
    s_add_u32 s59, s59, 143360
    v_add_u32 v154, s59, v1
    v_lshrrev_b32 v16, 2, v0
    v_and_b32 v17, 3, v0
    v_lshlrev_b32 v18, 4, v17
    v_lshl_add_u32 v104, v16, 10, v18
    v_lshrrev_b32 v18, 5, v0
    v_bfe_u32 v16, v0, 2, 2
    v_lshl_add_u32 v16, v18, 2, v16
    v_bfe_u32 v18, v0, 4, 1
    v_lshlrev_b32 v18, 5, v18
    v_lshl_add_u32 v16, v16, 6, v18
    v_lshl_add_u32 v16, v17, 3, v16
    s_and_b32 s59, s3, 3
    s_lshl_b32 s59, s59, 10
    s_add_u32 s59, s59, 151552
    v_add_u32 v105, s59, v16

    s_barrier
    s_bfe_u32 s59, s54, 0x30004
    s_lshl_b32 s60, s59, 7
    s_add_u32 s60, s60, s55
    s_mul_i32 s61, s59, 196608

    s_add_u32 m0, s57, 32768
    s_add_u32 s61, s61, s56
    buffer_load_dwordx4 v2, s[24:27], s60 offen offset:0 lds
    buffer_load_dwordx4 v3, s[24:27], s60 offen offset:1024 lds
    buffer_load_dwordx4 v4, s[24:27], s60 offen offset:2048 lds
    buffer_load_dwordx4 v5, s[24:27], s60 offen offset:3072 lds
    s_add_u32 m0, s58, 12288
    s_nop 0
    buffer_load_dwordx4 v6, s[28:31], s61 offen offset:2048 lds
    s_and_b32 s59, s3, 3
    s_lshl_b32 s55, s53, 18
    s_lshl_b32 s60, s59, 16
    s_add_u32 s55, s55, s60
    s_lshl_b32 s57, s59, 13

    s_waitcnt vmcnt(5) lgkmcnt(0)
    s_barrier
    s_cmp_lg_u32 s2, 0
    s_cbranch_scc1 gated_mix__softmax_full_mha__softmax_full_mha__prompt_kernel_noflag
    s_cmp_lg_u32 s3, 7
    s_cbranch_scc1 gated_mix__softmax_full_mha__softmax_full_mha__prompt_kernel_noflag
    s_mov_b64 exec, 1
    buffer_store_dword v161, off, s[48:51], 0 sc1
    s_mov_b64 exec, -1

gated_mix__softmax_full_mha__softmax_full_mha__prompt_kernel_noflag:
    s_bfe_u32 s59, s54, 0x30008
    s_lshl_b32 s60, s59, 7
    s_add_u32 s60, s60, s55
    s_mul_i32 s61, s59, 196608

    s_add_u32 m0, s57, 65536
    s_add_u32 s61, s61, s56
    buffer_load_dwordx4 v2, s[24:27], s60 offen offset:0 lds
    buffer_load_dwordx4 v3, s[24:27], s60 offen offset:1024 lds
    buffer_load_dwordx4 v4, s[24:27], s60 offen offset:2048 lds
    buffer_load_dwordx4 v5, s[24:27], s60 offen offset:3072 lds
    s_add_u32 m0, s57, 69632
    s_add_u32 s60, s60, 32768
    buffer_load_dwordx4 v2, s[24:27], s60 offen offset:0 lds
    buffer_load_dwordx4 v3, s[24:27], s60 offen offset:1024 lds
    buffer_load_dwordx4 v4, s[24:27], s60 offen offset:2048 lds
    buffer_load_dwordx4 v5, s[24:27], s60 offen offset:3072 lds
    s_add_u32 m0, s58, 24576
    s_nop 0
    buffer_load_dwordx4 v6, s[28:31], s61 offen offset:0 lds
    buffer_load_dwordx4 v6, s[28:31], s61 offen offset:1024 lds
    buffer_load_dwordx4 v6, s[28:31], s61 offen offset:2048 lds
    s_and_b32 s59, s3, 3
    s_lshl_b32 s60, s59, 10
    s_add_u32 m0, s60, 151552
    s_and_b32 s60, s2, 3
    s_lshl_b32 s60, s60, 2
    s_add_u32 s59, s59, s60
    s_lshl_b32 s59, s59, 6
    s_bfe_u32 s60, s2, 0x50002
    s_lshl_b32 s60, s60, 14
    s_add_u32 s59, s59, s60
    buffer_load_dwordx4 v104, s[36:39], s59 offen lds

    s_bfe_u32 s59, s54, 0x30000
    s_lshl_b32 s59, s59, 7
    buffer_load_dwordx4 v[64:67], v10, s[44:47], s59 offen
    s_bfe_u32 s59, s54, 0x30004
    s_lshl_b32 s59, s59, 7
    buffer_load_dwordx4 v[68:71], v10, s[44:47], s59 offen
    s_bfe_u32 s59, s54, 0x30008
    s_lshl_b32 s59, s59, 7
    buffer_load_dwordx4 v[72:75], v10, s[44:47], s59 offen
    s_bfe_u32 s59, s54, 0x3000c
    s_lshl_b32 s59, s59, 7
    buffer_load_dwordx4 v[76:79], v10, s[44:47], s59 offen
    s_bfe_u32 s59, s54, 0x30010
    s_lshl_b32 s59, s59, 7
    buffer_load_dwordx4 v[80:83], v10, s[44:47], s59 offen
    s_bfe_u32 s59, s54, 0x30014
    s_lshl_b32 s59, s59, 7
    buffer_load_dwordx4 v[84:87], v10, s[44:47], s59 offen
    s_bfe_u32 s59, s54, 0x30018
    s_lshl_b32 s59, s59, 7
    buffer_load_dwordx4 v[88:91], v10, s[44:47], s59 offen
    s_bfe_u32 s59, s54, 0x3001c
    s_lshl_b32 s59, s59, 7
    buffer_load_dwordx4 v[92:95], v10, s[44:47], s59 offen
    ds_read_b128 v[24:27], v7 offset:0
    s_waitcnt vmcnt(20) lgkmcnt(0)
    s_barrier
    s_bfe_u32 s59, s54, 0x3000c
    s_lshl_b32 s60, s59, 7
    s_add_u32 s60, s60, s55
    s_mul_i32 s61, s59, 196608

    s_add_u32 m0, s57, 0
    s_add_u32 s61, s61, s56
    buffer_load_dwordx4 v2, s[24:27], s60 offen offset:0 lds
    buffer_load_dwordx4 v3, s[24:27], s60 offen offset:1024 lds
    buffer_load_dwordx4 v4, s[24:27], s60 offen offset:2048 lds
    buffer_load_dwordx4 v5, s[24:27], s60 offen offset:3072 lds
    s_add_u32 m0, s57, 4096
    s_add_u32 s60, s60, 32768
    buffer_load_dwordx4 v2, s[24:27], s60 offen offset:0 lds
    buffer_load_dwordx4 v3, s[24:27], s60 offen offset:1024 lds
    buffer_load_dwordx4 v4, s[24:27], s60 offen offset:2048 lds
    buffer_load_dwordx4 v5, s[24:27], s60 offen offset:3072 lds
    s_add_u32 m0, s58, 0
    s_nop 0
    buffer_load_dwordx4 v6, s[28:31], s61 offen offset:0 lds
    buffer_load_dwordx4 v6, s[28:31], s61 offen offset:1024 lds
    buffer_load_dwordx4 v6, s[28:31], s61 offen offset:2048 lds
    ds_read_b128 v[28:31], v7 offset:32768
    s_waitcnt vmcnt(20) lgkmcnt(0)
    s_barrier
    s_bfe_u32 s59, s54, 0x30010
    s_lshl_b32 s60, s59, 7
    s_add_u32 s60, s60, s55
    s_mul_i32 s61, s59, 196608

    s_add_u32 m0, s57, 32768
    s_add_u32 s61, s61, s56
    buffer_load_dwordx4 v2, s[24:27], s60 offen offset:0 lds
    buffer_load_dwordx4 v3, s[24:27], s60 offen offset:1024 lds
    buffer_load_dwordx4 v4, s[24:27], s60 offen offset:2048 lds
    buffer_load_dwordx4 v5, s[24:27], s60 offen offset:3072 lds
    s_add_u32 m0, s57, 36864
    s_add_u32 s60, s60, 32768
    buffer_load_dwordx4 v2, s[24:27], s60 offen offset:0 lds
    buffer_load_dwordx4 v3, s[24:27], s60 offen offset:1024 lds
    buffer_load_dwordx4 v4, s[24:27], s60 offen offset:2048 lds
    buffer_load_dwordx4 v5, s[24:27], s60 offen offset:3072 lds
    s_add_u32 m0, s58, 12288
    s_nop 0
    buffer_load_dwordx4 v6, s[28:31], s61 offen offset:0 lds
    buffer_load_dwordx4 v6, s[28:31], s61 offen offset:1024 lds
    buffer_load_dwordx4 v6, s[28:31], s61 offen offset:2048 lds
    ds_read_b128 v[32:35], v9 offset:0
    s_waitcnt vmcnt(11) lgkmcnt(0)
    s_barrier
    s_bfe_u32 s59, s54, 0x30014
    s_lshl_b32 s60, s59, 7
    s_add_u32 s60, s60, s55
    s_mul_i32 s61, s59, 196608

    s_add_u32 m0, s57, 65536
    s_add_u32 s61, s61, s56
    buffer_load_dwordx4 v2, s[24:27], s60 offen offset:0 lds
    buffer_load_dwordx4 v3, s[24:27], s60 offen offset:1024 lds
    buffer_load_dwordx4 v4, s[24:27], s60 offen offset:2048 lds
    buffer_load_dwordx4 v5, s[24:27], s60 offen offset:3072 lds
    s_add_u32 m0, s57, 69632
    s_add_u32 s60, s60, 32768
    buffer_load_dwordx4 v2, s[24:27], s60 offen offset:0 lds
    buffer_load_dwordx4 v3, s[24:27], s60 offen offset:1024 lds
    buffer_load_dwordx4 v4, s[24:27], s60 offen offset:2048 lds
    buffer_load_dwordx4 v5, s[24:27], s60 offen offset:3072 lds
    s_add_u32 m0, s58, 24576
    s_nop 0
    buffer_load_dwordx4 v6, s[28:31], s61 offen offset:0 lds
    buffer_load_dwordx4 v6, s[28:31], s61 offen offset:1024 lds
    buffer_load_dwordx4 v6, s[28:31], s61 offen offset:2048 lds
    v_mov_b32 v166, 1
    s_cmp_lg_u32 s3, 4
    s_cbranch_scc1 gated_mix__softmax_full_mha__softmax_full_mha__prompt_kernel_nochk
    buffer_load_dword v166, off, s[48:51], 0 sc1
    s_branch gated_mix__softmax_full_mha__softmax_full_mha__prompt_kernel_chkd

gated_mix__softmax_full_mha__softmax_full_mha__prompt_kernel_nochk:
    buffer_load_dword v250, off, s[44:47], 0
gated_mix__softmax_full_mha__softmax_full_mha__prompt_kernel_chkd:
    ds_read_b128 v[36:39], v7 offset:0
    s_waitcnt vmcnt(12) lgkmcnt(0)
    s_barrier
    s_bfe_u32 s59, s54, 0x30018
    s_lshl_b32 s60, s59, 7
    s_add_u32 s60, s60, s55
    s_mul_i32 s61, s59, 196608

    s_add_u32 m0, s57, 0
    s_add_u32 s61, s61, s56
    buffer_load_dwordx4 v2, s[24:27], s60 offen offset:0 lds
    buffer_load_dwordx4 v3, s[24:27], s60 offen offset:1024 lds
    buffer_load_dwordx4 v4, s[24:27], s60 offen offset:2048 lds
    buffer_load_dwordx4 v5, s[24:27], s60 offen offset:3072 lds
    s_add_u32 m0, s57, 4096
    s_add_u32 s60, s60, 32768
    buffer_load_dwordx4 v2, s[24:27], s60 offen offset:0 lds
    buffer_load_dwordx4 v3, s[24:27], s60 offen offset:1024 lds
    buffer_load_dwordx4 v4, s[24:27], s60 offen offset:2048 lds
    buffer_load_dwordx4 v5, s[24:27], s60 offen offset:3072 lds
    s_add_u32 m0, s58, 0
    s_nop 0
    buffer_load_dwordx4 v6, s[28:31], s61 offen offset:0 lds
    buffer_load_dwordx4 v6, s[28:31], s61 offen offset:1024 lds
    buffer_load_dwordx4 v6, s[28:31], s61 offen offset:2048 lds
    ds_read_b128 v[40:43], v7 offset:32768
    s_waitcnt vmcnt(12) lgkmcnt(0)
    s_barrier
    s_bfe_u32 s59, s54, 0x3001c
    s_lshl_b32 s60, s59, 7
    s_add_u32 s60, s60, s55
    s_mul_i32 s61, s59, 196608

    s_add_u32 m0, s57, 32768
    s_add_u32 s61, s61, s56
    buffer_load_dwordx4 v2, s[24:27], s60 offen offset:0 lds
    buffer_load_dwordx4 v3, s[24:27], s60 offen offset:1024 lds
    buffer_load_dwordx4 v4, s[24:27], s60 offen offset:2048 lds
    buffer_load_dwordx4 v5, s[24:27], s60 offen offset:3072 lds
    s_add_u32 m0, s57, 36864
    s_add_u32 s60, s60, 32768
    buffer_load_dwordx4 v2, s[24:27], s60 offen offset:0 lds
    buffer_load_dwordx4 v3, s[24:27], s60 offen offset:1024 lds
    buffer_load_dwordx4 v4, s[24:27], s60 offen offset:2048 lds
    buffer_load_dwordx4 v5, s[24:27], s60 offen offset:3072 lds
    s_add_u32 m0, s58, 12288
    s_nop 0
    buffer_load_dwordx4 v6, s[28:31], s61 offen offset:0 lds
    buffer_load_dwordx4 v6, s[28:31], s61 offen offset:1024 lds
    buffer_load_dwordx4 v6, s[28:31], s61 offen offset:2048 lds
    ds_read_b128 v[44:47], v9 offset:0
    s_waitcnt vmcnt(11) lgkmcnt(0)
    s_barrier
    ds_read_b128 v[48:51], v7 offset:0
    s_waitcnt vmcnt(0) lgkmcnt(0)
    s_barrier
    ds_read_b64_tr_b16 v[100:101], v105
    ds_read_b64_tr_b16 v[102:103], v105 offset:512
    s_and_b32 s59, s2, 3
    s_lshl_b32 s59, s59, 1
    s_bfe_u32 s60, s3, 0x10001
    s_add_u32 s59, s59, s60
    s_bfe_u32 s60, s2, 0x20005
    s_sub_u32 s60, s60, s59
    s_and_b32 s60, s60, 3
    s_lshl_b32 s60, s60, 13
    s_lshl_b32 s59, s59, 17
    s_add_u32 s59, s59, s60
    s_bfe_u32 s60, s2, 0x10002
    s_lshl_b32 s60, s60, 16
    s_add_u32 s59, s59, s60
    s_lshr_b32 s60, s2, 7
    s_lshl_b32 s60, s60, 15
    s_add_u32 s59, s59, s60
    s_bfe_u32 s60, s2, 0x20003
    s_lshl_b32 s60, s60, 11
    s_add_u32 s59, s59, s60
    s_and_b32 s60, s3, 1
    s_lshl_b32 s60, s60, 8
    s_add_u32 s59, s59, s60
    s_add_u32 s59, s59, 12582912
    v_and_b32 v16, 15, v0
    v_bfe_u32 v17, v0, 4, 1
    v_lshrrev_b32 v18, 5, v0
    v_lshl_or_b32 v19, v16, 1, v17
    v_lshl_or_b32 v19, v18, 5, v19
    v_lshlrev_b32 v19, 2, v19
    v_lshlrev_b32 v16, 4, v16
    v_lshl_or_b32 v16, v17, 10, v16
    v_lshl_or_b32 v16, v18, 9, v16
    s_waitcnt lgkmcnt(0)
    ds_bpermute_b32 v100, v19, v100
    ds_bpermute_b32 v101, v19, v101
    ds_bpermute_b32 v102, v19, v102
    ds_bpermute_b32 v103, v19, v103
    s_waitcnt lgkmcnt(0)
    buffer_store_dwordx4 v[100:103], v16, s[32:35], s59 offen sc1

    ds_read_b128 v[52:55], v7 offset:32768
    s_waitcnt vmcnt(1) lgkmcnt(0)
    s_cmp_ge_u32 s52, 16
    s_cselect_b32 s61, 0, 0x80000000
    s_xor_b32 s61, s61, 0x3fb8aa3b

    v_dot2_f32_bf16 v8, v24, v64, v8
    v_dot2_f32_bf16 v8, v25, v65, v8
    v_dot2_f32_bf16 v8, v26, v66, v8
    v_dot2_f32_bf16 v8, v27, v67, v8
    v_dot2_f32_bf16 v8, v28, v68, v8
    v_dot2_f32_bf16 v8, v29, v69, v8
    v_dot2_f32_bf16 v8, v30, v70, v8
    v_dot2_f32_bf16 v8, v31, v71, v8
    v_dot2_f32_bf16 v8, v32, v72, v8
    v_dot2_f32_bf16 v8, v33, v73, v8
    v_dot2_f32_bf16 v8, v34, v74, v8
    v_dot2_f32_bf16 v8, v35, v75, v8
    v_dot2_f32_bf16 v8, v36, v76, v8
    v_dot2_f32_bf16 v8, v37, v77, v8
    v_dot2_f32_bf16 v8, v38, v78, v8
    v_dot2_f32_bf16 v8, v39, v79, v8
    v_dot2_f32_bf16 v8, v40, v80, v8
    v_dot2_f32_bf16 v8, v41, v81, v8
    v_dot2_f32_bf16 v8, v42, v82, v8
    v_dot2_f32_bf16 v8, v43, v83, v8
    v_dot2_f32_bf16 v8, v44, v84, v8
    v_dot2_f32_bf16 v8, v45, v85, v8
    v_dot2_f32_bf16 v8, v46, v86, v8
    v_dot2_f32_bf16 v8, v47, v87, v8
    v_dot2_f32_bf16 v8, v48, v88, v8
    v_dot2_f32_bf16 v8, v49, v89, v8
    v_dot2_f32_bf16 v8, v50, v90, v8
    v_dot2_f32_bf16 v8, v51, v91, v8
    v_dot2_f32_bf16 v8, v52, v92, v8
    v_dot2_f32_bf16 v8, v53, v93, v8
    v_dot2_f32_bf16 v8, v54, v94, v8
    v_dot2_f32_bf16 v8, v55, v95, v8
    s_lshr_b32 s59, s52, 3
    s_lshl_b32 s59, s59, 5
    s_lshl_b32 s60, s53, 2
    v_add_f32_dpp v8, v8, v8 quad_perm:[1,0,3,2] row_mask:0xf bank_mask:0xf
    s_add_u32 s59, s59, s60
    s_and_b32 s60, s3, 3
    v_add_f32_dpp v8, v8, v8 quad_perm:[2,3,0,1] row_mask:0xf bank_mask:0xf
    s_add_u32 s59, s59, s60
    s_lshl_b32 s59, s59, 3
    v_add_f32_dpp v8, v8, v8 row_half_mirror row_mask:0xf bank_mask:0xf
    s_and_b32 s60, s52, 7
    s_add_u32 s59, s59, s60
    v_mul_f32 v8, s61, v8
    v_exp_f32 v8, v8
    s_lshl_b32 s59, s59, 7
    v_add_f32 v8, 1.0, v8
    v_rcp_f32 v8, v8
    s_add_u32 s59, s59, 13631488
    v_lshrrev_b32 v16, 3, v0
    v_lshlrev_b32 v16, 2, v16
    s_mov_b32 exec_lo, 0x01010101
    s_mov_b32 exec_hi, 0x01010101
    buffer_store_dword v8, v16, s[32:35], s59 offen sc1
    s_mov_b64 exec, -1

gated_mix__softmax_full_mha__softmax_full_mha__prompt_kernel_rdy_chk:
    v_readfirstlane_b32 s59, v166
    s_cmp_ge_u32 s59, 1
    s_cbranch_scc1 gated_mix__softmax_full_mha__softmax_full_mha__prompt_kernel_rdy_ok
    s_add_u32 s18, s18, 1
    s_cmp_ge_u32 s18, 262144
    s_cbranch_scc1 gated_mix__softmax_full_mha__softmax_full_mha__prompt_kernel_rdy_ok
    buffer_load_dword v166, off, s[48:51], 0 sc1
    s_waitcnt vmcnt(0)
    s_branch gated_mix__softmax_full_mha__softmax_full_mha__prompt_kernel_rdy_chk

gated_mix__softmax_full_mha__softmax_full_mha__prompt_kernel_rdy_ok:
    s_barrier
    ds_read_b128 v[200:203], v154
    ds_read_b128 v[204:207], v154 offset:1024
gated_mix__softmax_full_mha__softmax_full_mha__prompt_kernel_attn:
    ds_read_b128 v[16:19], v159 offset:0
    ds_read_b128 v[24:27], v160 offset:0
    s_mov_b32 s8, 3
    s_cmp_eq_u32 s3, 0
    s_cselect_b32 s23, 3, 0
    s_cmp_eq_u32 s3, 4
    s_cselect_b32 s0, 1, 0

    s_waitcnt lgkmcnt(0)
    v_mfma_f32_32x32x16_bf16 v[32:47], v[16:19], v[200:203], 4.0
    s_nop 11
    v_exp_f32 v32, v32
    v_exp_f32 v33, v33
    s_setprio 3
    v_exp_f32 v34, v34
    v_exp_f32 v35, v35
    v_exp_f32 v36, v36
    v_mfma_f32_32x32x16_bf16 v[48:63], v[16:19], v[204:207], 4.0
    ds_read_b128 v[16:19], v159 offset:1024
    ds_read_b128 v[20:23], v160 offset:512
    ds_read_b128 v[28:31], v160 offset:1024
    v_exp_f32 v37, v37
    v_exp_f32 v38, v38
    v_exp_f32 v39, v39
    v_exp_f32 v40, v40
    v_exp_f32 v41, v41
    v_smfmac_f32_32x32x32_bf16 v[168:183], v[24:27], v[32:39], v158
    v_exp_f32 v42, v42
    v_exp_f32 v43, v43
    v_exp_f32 v44, v44
    v_exp_f32 v45, v45
    v_exp_f32 v46, v46
    v_exp_f32 v47, v47
    v_exp_f32 v48, v48
    v_exp_f32 v49, v49
    s_waitcnt lgkmcnt(0)
    v_smfmac_f32_32x32x32_bf16 v[168:183], v[20:23], v[40:47], v158
    v_exp_f32 v50, v50
    v_exp_f32 v51, v51
    v_exp_f32 v52, v52
    v_mfma_f32_32x32x16_bf16 v[32:47], v[16:19], v[200:203], 4.0
    v_exp_f32 v53, v53
    v_exp_f32 v54, v54
    v_exp_f32 v55, v55
    v_exp_f32 v56, v56
    v_exp_f32 v57, v57
    v_smfmac_f32_32x32x32_bf16 v[184:199], v[24:27], v[48:55], v158
    v_exp_f32 v58, v58
    v_exp_f32 v59, v59
    v_exp_f32 v60, v60
    v_exp_f32 v61, v61
    v_exp_f32 v62, v62
    v_exp_f32 v63, v63
    v_exp_f32 v32, v32
    v_exp_f32 v33, v33
    v_smfmac_f32_32x32x32_bf16 v[184:199], v[20:23], v[56:63], v158
    v_exp_f32 v34, v34
    v_exp_f32 v35, v35
    v_exp_f32 v36, v36
    v_mfma_f32_32x32x16_bf16 v[48:63], v[16:19], v[204:207], 4.0
    ds_read_b128 v[16:19], v159 offset:2048
    ds_read_b128 v[20:23], v160 offset:1536
    ds_read_b128 v[24:27], v160 offset:2048
    v_exp_f32 v37, v37
    v_exp_f32 v38, v38
    v_exp_f32 v39, v39
    v_exp_f32 v40, v40
    v_exp_f32 v41, v41
    v_smfmac_f32_32x32x32_bf16 v[168:183], v[28:31], v[32:39], v158
    v_exp_f32 v42, v42
    v_exp_f32 v43, v43
    v_exp_f32 v44, v44
    v_exp_f32 v45, v45
    v_exp_f32 v46, v46
    v_exp_f32 v47, v47
    v_exp_f32 v48, v48
    v_exp_f32 v49, v49
    s_waitcnt lgkmcnt(0)
    v_smfmac_f32_32x32x32_bf16 v[168:183], v[20:23], v[40:47], v158
    v_exp_f32 v50, v50
    v_exp_f32 v51, v51
    v_exp_f32 v52, v52
    v_mfma_f32_32x32x16_bf16 v[32:47], v[16:19], v[200:203], 4.0
    v_exp_f32 v53, v53
    v_exp_f32 v54, v54
    v_exp_f32 v55, v55
    v_exp_f32 v56, v56
    v_exp_f32 v57, v57
    v_smfmac_f32_32x32x32_bf16 v[184:199], v[28:31], v[48:55], v158
    v_exp_f32 v58, v58
    v_exp_f32 v59, v59
    v_exp_f32 v60, v60
    v_exp_f32 v61, v61
    v_exp_f32 v62, v62
    v_exp_f32 v63, v63
    v_exp_f32 v32, v32
    v_exp_f32 v33, v33
    v_smfmac_f32_32x32x32_bf16 v[184:199], v[20:23], v[56:63], v158
    s_cmp_ge_u32 s3, 4
    s_cbranch_scc1 gated_mix__softmax_full_mha__softmax_full_mha__prompt_kernel_noadd
    s_waitcnt vmcnt(0)

    s_mov_b64 exec, 1
    ds_add_rtn_u32 v167, v165, v161
    s_add_u32 s60, s9, 16384
    s_waitcnt lgkmcnt(0)
    v_readfirstlane_b32 s59, v167
    s_cmp_lg_u32 s59, 3
    s_cbranch_scc1 gated_mix__softmax_full_mha__softmax_full_mha__prompt_kernel_notlast
    buffer_atomic_add v161, off, s[32:35], s60
    buffer_atomic_add v161, off, s[32:35], s9 sc1

gated_mix__softmax_full_mha__softmax_full_mha__prompt_kernel_notlast:
    s_mov_b64 exec, -1
gated_mix__softmax_full_mha__softmax_full_mha__prompt_kernel_noadd:
    v_exp_f32 v34, v34
    v_exp_f32 v35, v35
    v_exp_f32 v36, v36
    v_mfma_f32_32x32x16_bf16 v[48:63], v[16:19], v[204:207], 4.0
    ds_read_b128 v[16:19], v159 offset:3072
    ds_read_b128 v[20:23], v160 offset:2560
    ds_read_b128 v[28:31], v160 offset:3072
    v_exp_f32 v37, v37
    v_exp_f32 v38, v38
    v_exp_f32 v39, v39
    v_exp_f32 v40, v40
    v_exp_f32 v41, v41
    v_smfmac_f32_32x32x32_bf16 v[168:183], v[24:27], v[32:39], v158
    v_exp_f32 v42, v42
    v_exp_f32 v43, v43
    v_exp_f32 v44, v44
    v_exp_f32 v45, v45
    v_exp_f32 v46, v46
    v_exp_f32 v47, v47
    v_exp_f32 v48, v48
    v_exp_f32 v49, v49
    s_waitcnt lgkmcnt(0)
    v_smfmac_f32_32x32x32_bf16 v[168:183], v[20:23], v[40:47], v158
    v_exp_f32 v50, v50
    v_exp_f32 v51, v51
    v_exp_f32 v52, v52
    v_mfma_f32_32x32x16_bf16 v[32:47], v[16:19], v[200:203], 4.0
    v_exp_f32 v53, v53
    v_exp_f32 v54, v54
    v_exp_f32 v55, v55
    v_exp_f32 v56, v56
    v_exp_f32 v57, v57
    v_smfmac_f32_32x32x32_bf16 v[184:199], v[24:27], v[48:55], v158
    v_exp_f32 v58, v58
    v_exp_f32 v59, v59
    v_exp_f32 v60, v60
    v_exp_f32 v61, v61
    v_exp_f32 v62, v62
    v_exp_f32 v63, v63
    v_exp_f32 v32, v32
    v_exp_f32 v33, v33
    v_smfmac_f32_32x32x32_bf16 v[184:199], v[20:23], v[56:63], v158
    v_exp_f32 v34, v34
    v_exp_f32 v35, v35
    v_exp_f32 v36, v36
    v_mfma_f32_32x32x16_bf16 v[48:63], v[16:19], v[204:207], 4.0
    ds_read_b128 v[16:19], v159 offset:4096
    ds_read_b128 v[20:23], v160 offset:3584
    ds_read_b128 v[24:27], v160 offset:4096
    v_exp_f32 v37, v37
    v_exp_f32 v38, v38
    v_exp_f32 v39, v39
    v_exp_f32 v40, v40
    v_exp_f32 v41, v41
    v_smfmac_f32_32x32x32_bf16 v[168:183], v[28:31], v[32:39], v158
    v_exp_f32 v42, v42
    v_exp_f32 v43, v43
    v_exp_f32 v44, v44
    v_exp_f32 v45, v45
    v_exp_f32 v46, v46
    v_exp_f32 v47, v47
    v_exp_f32 v48, v48
    v_exp_f32 v49, v49
    s_waitcnt lgkmcnt(0)
    v_smfmac_f32_32x32x32_bf16 v[168:183], v[20:23], v[40:47], v158
    v_exp_f32 v50, v50
    v_exp_f32 v51, v51
    v_exp_f32 v52, v52
    v_mfma_f32_32x32x16_bf16 v[32:47], v[16:19], v[200:203], 4.0
    v_exp_f32 v53, v53
    v_exp_f32 v54, v54
    v_exp_f32 v55, v55
    v_exp_f32 v56, v56
    v_exp_f32 v57, v57
    v_smfmac_f32_32x32x32_bf16 v[184:199], v[28:31], v[48:55], v158
    v_exp_f32 v58, v58
    v_exp_f32 v59, v59
    v_exp_f32 v60, v60
    v_exp_f32 v61, v61
    v_exp_f32 v62, v62
    v_exp_f32 v63, v63
    v_exp_f32 v32, v32
    v_exp_f32 v33, v33
    v_smfmac_f32_32x32x32_bf16 v[184:199], v[20:23], v[56:63], v158
    s_cmp_lg_u32 s3, 0
    s_cbranch_scc1 gated_mix__softmax_full_mha__softmax_full_mha__prompt_kernel_nopoll

    s_add_u32 s63, s9, 16384
    s_mov_b64 exec, 1
    v_mov_b32 v166, 0
    buffer_atomic_add v166, off, s[32:35], s63 sc0
    s_mov_b64 exec, -1

gated_mix__softmax_full_mha__softmax_full_mha__prompt_kernel_nopoll:
    v_exp_f32 v34, v34
    v_exp_f32 v35, v35
    v_exp_f32 v36, v36
    v_mfma_f32_32x32x16_bf16 v[48:63], v[16:19], v[204:207], 4.0
    ds_read_b128 v[16:19], v159 offset:5120
    ds_read_b128 v[20:23], v160 offset:4608
    ds_read_b128 v[28:31], v160 offset:5120
    v_exp_f32 v37, v37
    v_exp_f32 v38, v38
    v_exp_f32 v39, v39
    v_exp_f32 v40, v40
    v_exp_f32 v41, v41
    v_smfmac_f32_32x32x32_bf16 v[168:183], v[24:27], v[32:39], v158
    v_exp_f32 v42, v42
    v_exp_f32 v43, v43
    v_exp_f32 v44, v44
    v_exp_f32 v45, v45
    v_exp_f32 v46, v46
    v_exp_f32 v47, v47
    v_exp_f32 v48, v48
    v_exp_f32 v49, v49
    s_waitcnt lgkmcnt(0)
    v_smfmac_f32_32x32x32_bf16 v[168:183], v[20:23], v[40:47], v158
    v_exp_f32 v50, v50
    v_exp_f32 v51, v51
    v_exp_f32 v52, v52
    v_mfma_f32_32x32x16_bf16 v[32:47], v[16:19], v[200:203], 4.0
    v_exp_f32 v53, v53
    v_exp_f32 v54, v54
    v_exp_f32 v55, v55
    v_exp_f32 v56, v56
    v_exp_f32 v57, v57
    v_smfmac_f32_32x32x32_bf16 v[184:199], v[24:27], v[48:55], v158
    v_exp_f32 v58, v58
    v_exp_f32 v59, v59
    v_exp_f32 v60, v60
    v_exp_f32 v61, v61
    v_exp_f32 v62, v62
    v_exp_f32 v63, v63
    v_exp_f32 v32, v32
    v_exp_f32 v33, v33
    v_smfmac_f32_32x32x32_bf16 v[184:199], v[20:23], v[56:63], v158
    s_cmp_lg_u32 s3, 0
    s_cbranch_scc1 gated_mix__softmax_full_mha__softmax_full_mha__prompt_kernel_nopc
    s_waitcnt vmcnt(0)

gated_mix__softmax_full_mha__softmax_full_mha__prompt_kernel_kv_chk:
    v_readfirstlane_b32 s59, v166
    s_add_u32 s63, s9, 16384
    s_cmp_ge_u32 s59, 8
    s_cbranch_scc1 gated_mix__softmax_full_mha__softmax_full_mha__prompt_kernel_kv_ok
    s_add_u32 s18, s18, 1
    s_cmp_ge_u32 s18, 262144
    s_cbranch_scc1 gated_mix__softmax_full_mha__softmax_full_mha__prompt_kernel_kv_ok
    s_and_b32 s59, s18, 7
    s_cbranch_scc0 gated_mix__softmax_full_mha__softmax_full_mha__prompt_kernel_kv_far

    s_mov_b64 exec, 1
    v_mov_b32 v166, 0
    buffer_atomic_add v166, off, s[32:35], s63 sc0
    s_mov_b64 exec, -1

    s_waitcnt vmcnt(0)
    s_branch gated_mix__softmax_full_mha__softmax_full_mha__prompt_kernel_kv_chk

gated_mix__softmax_full_mha__softmax_full_mha__prompt_kernel_kv_far:
    buffer_load_dword v166, off, s[32:35], s9 sc0 sc1
    s_waitcnt vmcnt(0)
    s_branch gated_mix__softmax_full_mha__softmax_full_mha__prompt_kernel_kv_chk

gated_mix__softmax_full_mha__softmax_full_mha__prompt_kernel_kv_ok:
    ds_write_b32 v165, v161 offset:4
gated_mix__softmax_full_mha__softmax_full_mha__prompt_kernel_nopc:
    s_cmp_ge_u32 s3, 4
    s_cbranch_scc1 gated_mix__softmax_full_mha__softmax_full_mha__prompt_kernel_nogo

    s_setprio 0
gated_mix__softmax_full_mha__softmax_full_mha__prompt_kernel_go_chk:
    ds_read_b32 v167, v165 offset:4
    s_waitcnt lgkmcnt(0)
    v_readfirstlane_b32 s59, v167
    s_cmp_eq_u32 s59, 0
    s_cbranch_scc1 gated_mix__softmax_full_mha__softmax_full_mha__prompt_kernel_go_chk

    s_setprio 3
    s_lshl_b32 s60, s3, 12
    s_add_u32 s59, s4, s5
    s_add_u32 s60, s60, 0
    s_add_u32 m0, s6, s60
    s_add_u32 s59, s59, s60

    buffer_load_dwordx4 v1, s[32:35], s59 offen offset:0 sc1 lds
    buffer_load_dwordx4 v1, s[32:35], s59 offen offset:1024 sc1 lds
    buffer_load_dwordx4 v1, s[32:35], s59 offen offset:2048 sc1 lds
    buffer_load_dwordx4 v1, s[32:35], s59 offen offset:3072 sc1 lds
gated_mix__softmax_full_mha__softmax_full_mha__prompt_kernel_nogo:
    v_exp_f32 v34, v34
    v_exp_f32 v35, v35
    v_exp_f32 v36, v36
    v_mfma_f32_32x32x16_bf16 v[48:63], v[16:19], v[204:207], 4.0
    ds_read_b128 v[16:19], v159 offset:6144
    ds_read_b128 v[20:23], v160 offset:5632
    ds_read_b128 v[24:27], v160 offset:6144
    v_exp_f32 v37, v37
    v_exp_f32 v38, v38
    v_exp_f32 v39, v39
    v_exp_f32 v40, v40
    v_exp_f32 v41, v41
    v_smfmac_f32_32x32x32_bf16 v[168:183], v[28:31], v[32:39], v158
    v_exp_f32 v42, v42
    v_exp_f32 v43, v43
    v_exp_f32 v44, v44
    v_exp_f32 v45, v45
    v_exp_f32 v46, v46
    v_exp_f32 v47, v47
    v_exp_f32 v48, v48
    v_exp_f32 v49, v49
    s_waitcnt lgkmcnt(0)
    v_smfmac_f32_32x32x32_bf16 v[168:183], v[20:23], v[40:47], v158
    s_cmp_ge_u32 s3, 4
    s_cbranch_scc1 gated_mix__softmax_full_mha__softmax_full_mha__prompt_kernel_nogo2

    s_lshl_b32 s60, s3, 12
    s_add_u32 s59, s4, s5
    s_add_u32 s60, s60, 4096
    s_add_u32 m0, s6, s60
    s_add_u32 s59, s59, s60

    buffer_load_dwordx4 v1, s[32:35], s59 offen offset:0 sc1 lds
    buffer_load_dwordx4 v1, s[32:35], s59 offen offset:1024 sc1 lds
    buffer_load_dwordx4 v1, s[32:35], s59 offen offset:2048 sc1 lds
    buffer_load_dwordx4 v1, s[32:35], s59 offen offset:3072 sc1 lds
gated_mix__softmax_full_mha__softmax_full_mha__prompt_kernel_nogo2:
    s_setprio 2
    v_exp_f32 v50, v50
    v_exp_f32 v51, v51
    v_exp_f32 v52, v52
    v_mfma_f32_32x32x16_bf16 v[32:47], v[16:19], v[200:203], 4.0
    v_exp_f32 v53, v53
    v_exp_f32 v54, v54
    v_exp_f32 v55, v55
    v_exp_f32 v56, v56
    v_exp_f32 v57, v57
    v_smfmac_f32_32x32x32_bf16 v[184:199], v[28:31], v[48:55], v158
    v_exp_f32 v58, v58
    v_exp_f32 v59, v59
    v_exp_f32 v60, v60
    v_exp_f32 v61, v61
    v_exp_f32 v62, v62
    v_exp_f32 v63, v63
    v_exp_f32 v32, v32
    v_exp_f32 v33, v33
    v_smfmac_f32_32x32x32_bf16 v[184:199], v[20:23], v[56:63], v158
    v_exp_f32 v34, v34
    v_exp_f32 v35, v35
    v_exp_f32 v36, v36
    v_mfma_f32_32x32x16_bf16 v[48:63], v[16:19], v[204:207], 4.0
    ds_read_b128 v[16:19], v159 offset:7168
    ds_read_b128 v[20:23], v160 offset:6656
    ds_read_b128 v[28:31], v160 offset:7168
    v_exp_f32 v37, v37
    v_exp_f32 v38, v38
    v_exp_f32 v39, v39
    v_exp_f32 v40, v40
    v_exp_f32 v41, v41
    v_smfmac_f32_32x32x32_bf16 v[168:183], v[24:27], v[32:39], v158
    v_exp_f32 v42, v42
    v_exp_f32 v43, v43
    v_exp_f32 v44, v44
    v_exp_f32 v45, v45
    v_exp_f32 v46, v46
    v_exp_f32 v47, v47
    v_exp_f32 v48, v48
    v_exp_f32 v49, v49
    s_waitcnt lgkmcnt(0)
    v_smfmac_f32_32x32x32_bf16 v[168:183], v[20:23], v[40:47], v158
    s_setprio 1
    v_exp_f32 v50, v50
    v_exp_f32 v51, v51
    v_exp_f32 v52, v52
    v_mfma_f32_32x32x16_bf16 v[32:47], v[16:19], v[200:203], 4.0
    v_exp_f32 v53, v53
    v_exp_f32 v54, v54
    v_exp_f32 v55, v55
    v_exp_f32 v56, v56
    v_exp_f32 v57, v57
    v_smfmac_f32_32x32x32_bf16 v[184:199], v[24:27], v[48:55], v158
    s_setprio 0
    v_exp_f32 v58, v58
    v_exp_f32 v59, v59
    v_exp_f32 v60, v60
    v_exp_f32 v61, v61
    v_exp_f32 v62, v62
    v_exp_f32 v63, v63
    v_exp_f32 v32, v32
    v_exp_f32 v33, v33
    v_smfmac_f32_32x32x32_bf16 v[184:199], v[20:23], v[56:63], v158
    v_exp_f32 v34, v34
    v_exp_f32 v35, v35
    v_exp_f32 v36, v36
    v_mfma_f32_32x32x16_bf16 v[48:63], v[16:19], v[204:207], 4.0
    s_waitcnt vmcnt(0)
    s_barrier
    s_add_u32 s5, s5, 32768
    s_and_b32 s5, s5, 0x3ffff
    s_lshl_b32 s61, s53, 15
    s_cmp_eq_u32 s5, s61
    s_cselect_b32 s61, 32768, 0
    s_add_u32 s5, s5, s61
    s_and_b32 s5, s5, 0x3ffff

    s_add_u32 s6, s6, 32768
    s_setprio 3
    ds_read_b128 v[20:23], v160 offset:7680
    v_add_u32 v159, s7, v155
    v_mad_u32_u24 v160, v157, s7, v156
    s_add_u32 s7, s7, 32768
    s_and_b32 s7, s7, 0x1ffff
    ds_read_b128 v[16:19], v159 offset:0
    ds_read_b128 v[24:27], v160 offset:0
    v_mov_b32 v64, -1
    v_mov_b32 v65, -1
    v_mov_b32 v66, -1
    v_mov_b32 v67, -1
    buffer_store_dwordx4 v[64:67], v1, s[32:35], s10 offen sc1
    v_exp_f32 v37, v37
    v_exp_f32 v38, v38
    v_exp_f32 v39, v39
    v_exp_f32 v40, v40
    v_exp_f32 v41, v41
    v_smfmac_f32_32x32x32_bf16 v[168:183], v[28:31], v[32:39], v158
    v_exp_f32 v42, v42
    v_exp_f32 v43, v43
    v_exp_f32 v44, v44
    v_exp_f32 v45, v45
    v_exp_f32 v46, v46
    v_exp_f32 v47, v47
    v_exp_f32 v48, v48
    v_exp_f32 v49, v49
    s_waitcnt lgkmcnt(0)
    v_smfmac_f32_32x32x32_bf16 v[168:183], v[20:23], v[40:47], v158
    v_exp_f32 v50, v50
    v_exp_f32 v51, v51
    v_exp_f32 v52, v52
    v_mfma_f32_32x32x16_bf16 v[32:47], v[16:19], v[200:203], 4.0
    buffer_store_dwordx4 v[64:67], v1, s[32:35], s11 offen sc1
    v_exp_f32 v53, v53
    v_exp_f32 v54, v54
    v_exp_f32 v55, v55
    v_exp_f32 v56, v56
    v_exp_f32 v57, v57
    v_smfmac_f32_32x32x32_bf16 v[184:199], v[28:31], v[48:55], v158
    v_exp_f32 v58, v58
    v_exp_f32 v59, v59
    v_exp_f32 v60, v60
    v_exp_f32 v61, v61
    v_exp_f32 v62, v62
    v_exp_f32 v63, v63
    v_exp_f32 v32, v32
    v_exp_f32 v33, v33
    v_smfmac_f32_32x32x32_bf16 v[184:199], v[20:23], v[56:63], v158
.p2align 3
gated_mix__softmax_full_mha__softmax_full_mha__prompt_kernel_mid:
    s_cmp_eq_u32 s8, s0
    s_cbranch_scc1 gated_mix__softmax_full_mha__softmax_full_mha__prompt_kernel_late0
gated_mix__softmax_full_mha__softmax_full_mha__prompt_kernel_late0_back:
    s_mov_b32 m0, s6
    s_add_u32 s57, s4, s5

    s_add_u32 s5, s5, 32768
    s_and_b32 s5, s5, 0x3ffff
    s_lshl_b32 s61, s53, 15
    s_cmp_eq_u32 s5, s61
    s_cselect_b32 s61, 32768, 0
    s_add_u32 s5, s5, s61
    s_and_b32 s5, s5, 0x3ffff

    s_add_u32 s6, s6, 32768
    s_and_b32 s6, s6, 0x1ffff

    v_exp_f32 v34, v34
    v_exp_f32 v35, v35
    v_exp_f32 v36, v36
    v_mfma_f32_32x32x16_bf16 v[48:63], v[16:19], v[204:207], 4.0
    ds_read_b128 v[16:19], v159 offset:1024
    ds_read_b128 v[20:23], v160 offset:512
    ds_read_b128 v[28:31], v160 offset:1024
    buffer_load_dwordx4 v1, s[32:35], s57 offen offset:0 sc1 lds
    v_exp_f32 v37, v37
    v_exp_f32 v38, v38
    v_exp_f32 v39, v39
    v_exp_f32 v40, v40
    v_exp_f32 v41, v41
    v_smfmac_f32_32x32x32_bf16 v[168:183], v[24:27], v[32:39], v158
    v_exp_f32 v42, v42
    v_exp_f32 v43, v43
    v_exp_f32 v44, v44
    v_exp_f32 v45, v45
    v_exp_f32 v46, v46
    v_exp_f32 v47, v47
    v_exp_f32 v48, v48
    v_exp_f32 v49, v49
    s_waitcnt lgkmcnt(0)
    v_smfmac_f32_32x32x32_bf16 v[168:183], v[20:23], v[40:47], v158
    v_exp_f32 v50, v50
    v_exp_f32 v51, v51
    v_exp_f32 v52, v52
    v_mfma_f32_32x32x16_bf16 v[32:47], v[16:19], v[200:203], 4.0
    buffer_load_dwordx4 v1, s[32:35], s57 offen offset:1024 sc1 lds
    v_exp_f32 v53, v53
    v_exp_f32 v54, v54
    v_exp_f32 v55, v55
    v_exp_f32 v56, v56
    v_exp_f32 v57, v57
    v_smfmac_f32_32x32x32_bf16 v[184:199], v[24:27], v[48:55], v158
    v_exp_f32 v58, v58
    v_exp_f32 v59, v59
    v_exp_f32 v60, v60
    v_exp_f32 v61, v61
    v_exp_f32 v62, v62
    v_exp_f32 v63, v63
    v_exp_f32 v32, v32
    v_exp_f32 v33, v33
    v_smfmac_f32_32x32x32_bf16 v[184:199], v[20:23], v[56:63], v158
    v_exp_f32 v34, v34
    v_exp_f32 v35, v35
    v_exp_f32 v36, v36
    v_mfma_f32_32x32x16_bf16 v[48:63], v[16:19], v[204:207], 4.0
    ds_read_b128 v[16:19], v159 offset:2048
    ds_read_b128 v[20:23], v160 offset:1536
    ds_read_b128 v[24:27], v160 offset:2048
    buffer_load_dwordx4 v1, s[32:35], s57 offen offset:2048 sc1 lds
    v_exp_f32 v37, v37
    v_exp_f32 v38, v38
    v_exp_f32 v39, v39
    v_exp_f32 v40, v40
    v_exp_f32 v41, v41
    v_smfmac_f32_32x32x32_bf16 v[168:183], v[28:31], v[32:39], v158
    v_exp_f32 v42, v42
    v_exp_f32 v43, v43
    v_exp_f32 v44, v44
    v_exp_f32 v45, v45
    v_exp_f32 v46, v46
    v_exp_f32 v47, v47
    v_exp_f32 v48, v48
    v_exp_f32 v49, v49
    s_waitcnt lgkmcnt(0)
    v_smfmac_f32_32x32x32_bf16 v[168:183], v[20:23], v[40:47], v158
    v_exp_f32 v50, v50
    v_exp_f32 v51, v51
    v_exp_f32 v52, v52
    v_mfma_f32_32x32x16_bf16 v[32:47], v[16:19], v[200:203], 4.0
    buffer_load_dwordx4 v1, s[32:35], s57 offen offset:3072 sc1 lds
    v_exp_f32 v53, v53
    v_exp_f32 v54, v54
    v_exp_f32 v55, v55
    v_exp_f32 v56, v56
    v_exp_f32 v57, v57
    v_smfmac_f32_32x32x32_bf16 v[184:199], v[28:31], v[48:55], v158
    v_exp_f32 v58, v58
    v_exp_f32 v59, v59
    v_exp_f32 v60, v60
    v_exp_f32 v61, v61
    v_exp_f32 v62, v62
    v_exp_f32 v63, v63
    v_exp_f32 v32, v32
    v_exp_f32 v33, v33
    v_smfmac_f32_32x32x32_bf16 v[184:199], v[20:23], v[56:63], v158
    v_exp_f32 v34, v34
    v_exp_f32 v35, v35
    v_exp_f32 v36, v36
    v_mfma_f32_32x32x16_bf16 v[48:63], v[16:19], v[204:207], 4.0
    ds_read_b128 v[16:19], v159 offset:3072
    ds_read_b128 v[20:23], v160 offset:2560
    ds_read_b128 v[28:31], v160 offset:3072
    v_exp_f32 v37, v37
    v_exp_f32 v38, v38
    v_exp_f32 v39, v39
    v_exp_f32 v40, v40
    v_exp_f32 v41, v41
    v_smfmac_f32_32x32x32_bf16 v[168:183], v[24:27], v[32:39], v158
    v_exp_f32 v42, v42
    v_exp_f32 v43, v43
    v_exp_f32 v44, v44
    v_exp_f32 v45, v45
    v_exp_f32 v46, v46
    v_exp_f32 v47, v47
    v_exp_f32 v48, v48
    v_exp_f32 v49, v49
    s_waitcnt lgkmcnt(0)
    v_smfmac_f32_32x32x32_bf16 v[168:183], v[20:23], v[40:47], v158
    v_exp_f32 v50, v50
    v_exp_f32 v51, v51
    v_exp_f32 v52, v52
    v_mfma_f32_32x32x16_bf16 v[32:47], v[16:19], v[200:203], 4.0
    v_exp_f32 v53, v53
    v_exp_f32 v54, v54
    v_exp_f32 v55, v55
    v_exp_f32 v56, v56
    v_exp_f32 v57, v57
    v_smfmac_f32_32x32x32_bf16 v[184:199], v[24:27], v[48:55], v158
    v_exp_f32 v58, v58
    v_exp_f32 v59, v59
    v_exp_f32 v60, v60
    v_exp_f32 v61, v61
    v_exp_f32 v62, v62
    v_exp_f32 v63, v63
    v_exp_f32 v32, v32
    v_exp_f32 v33, v33
    v_smfmac_f32_32x32x32_bf16 v[184:199], v[20:23], v[56:63], v158
    v_exp_f32 v34, v34
    v_exp_f32 v35, v35
    v_exp_f32 v36, v36
    v_mfma_f32_32x32x16_bf16 v[48:63], v[16:19], v[204:207], 4.0
    ds_read_b128 v[16:19], v159 offset:4096
    ds_read_b128 v[20:23], v160 offset:3584
    ds_read_b128 v[24:27], v160 offset:4096
    v_exp_f32 v37, v37
    v_exp_f32 v38, v38
    v_exp_f32 v39, v39
    v_exp_f32 v40, v40
    v_exp_f32 v41, v41
    v_smfmac_f32_32x32x32_bf16 v[168:183], v[28:31], v[32:39], v158
    v_exp_f32 v42, v42
    v_exp_f32 v43, v43
    v_exp_f32 v44, v44
    v_exp_f32 v45, v45
    v_exp_f32 v46, v46
    v_exp_f32 v47, v47
    v_exp_f32 v48, v48
    v_exp_f32 v49, v49
    s_waitcnt lgkmcnt(0)
    v_smfmac_f32_32x32x32_bf16 v[168:183], v[20:23], v[40:47], v158
    v_exp_f32 v50, v50
    v_exp_f32 v51, v51
    v_exp_f32 v52, v52
    v_mfma_f32_32x32x16_bf16 v[32:47], v[16:19], v[200:203], 4.0
    v_exp_f32 v53, v53
    v_exp_f32 v54, v54
    v_exp_f32 v55, v55
    v_exp_f32 v56, v56
    v_exp_f32 v57, v57
    v_smfmac_f32_32x32x32_bf16 v[184:199], v[28:31], v[48:55], v158
    v_exp_f32 v58, v58
    v_exp_f32 v59, v59
    v_exp_f32 v60, v60
    v_exp_f32 v61, v61
    v_exp_f32 v62, v62
    v_exp_f32 v63, v63
    v_exp_f32 v32, v32
    v_exp_f32 v33, v33
    v_smfmac_f32_32x32x32_bf16 v[184:199], v[20:23], v[56:63], v158
    v_exp_f32 v34, v34
    v_exp_f32 v35, v35
    v_exp_f32 v36, v36
    v_mfma_f32_32x32x16_bf16 v[48:63], v[16:19], v[204:207], 4.0
    ds_read_b128 v[16:19], v159 offset:5120
    ds_read_b128 v[20:23], v160 offset:4608
    ds_read_b128 v[28:31], v160 offset:5120
    v_exp_f32 v37, v37
    v_exp_f32 v38, v38
    v_exp_f32 v39, v39
    v_exp_f32 v40, v40
    v_exp_f32 v41, v41
    v_smfmac_f32_32x32x32_bf16 v[168:183], v[24:27], v[32:39], v158
    v_exp_f32 v42, v42
    v_exp_f32 v43, v43
    v_exp_f32 v44, v44
    v_exp_f32 v45, v45
    v_exp_f32 v46, v46
    v_exp_f32 v47, v47
    v_exp_f32 v48, v48
    v_exp_f32 v49, v49
    s_waitcnt lgkmcnt(0)
    v_smfmac_f32_32x32x32_bf16 v[168:183], v[20:23], v[40:47], v158
    v_exp_f32 v50, v50
    v_exp_f32 v51, v51
    v_exp_f32 v52, v52
    v_mfma_f32_32x32x16_bf16 v[32:47], v[16:19], v[200:203], 4.0
    v_exp_f32 v53, v53
    v_exp_f32 v54, v54
    v_exp_f32 v55, v55
    v_exp_f32 v56, v56
    v_exp_f32 v57, v57
    v_smfmac_f32_32x32x32_bf16 v[184:199], v[24:27], v[48:55], v158
    v_exp_f32 v58, v58
    v_exp_f32 v59, v59
    v_exp_f32 v60, v60
    v_exp_f32 v61, v61
    v_exp_f32 v62, v62
    v_exp_f32 v63, v63
    v_exp_f32 v32, v32
    v_exp_f32 v33, v33
    v_smfmac_f32_32x32x32_bf16 v[184:199], v[20:23], v[56:63], v158
    v_exp_f32 v34, v34
    v_exp_f32 v35, v35
    v_exp_f32 v36, v36
    v_mfma_f32_32x32x16_bf16 v[48:63], v[16:19], v[204:207], 4.0
    ds_read_b128 v[16:19], v159 offset:6144
    ds_read_b128 v[20:23], v160 offset:5632
    ds_read_b128 v[24:27], v160 offset:6144
    v_exp_f32 v37, v37
    v_exp_f32 v38, v38
    v_exp_f32 v39, v39
    v_exp_f32 v40, v40
    v_exp_f32 v41, v41
    v_smfmac_f32_32x32x32_bf16 v[168:183], v[28:31], v[32:39], v158
    v_exp_f32 v42, v42
    v_exp_f32 v43, v43
    v_exp_f32 v44, v44
    v_exp_f32 v45, v45
    v_exp_f32 v46, v46
    v_exp_f32 v47, v47
    v_exp_f32 v48, v48
    v_exp_f32 v49, v49
    s_waitcnt lgkmcnt(0)
    v_smfmac_f32_32x32x32_bf16 v[168:183], v[20:23], v[40:47], v158
    s_setprio 2
    v_exp_f32 v50, v50
    v_exp_f32 v51, v51
    v_exp_f32 v52, v52
    v_mfma_f32_32x32x16_bf16 v[32:47], v[16:19], v[200:203], 4.0
    v_exp_f32 v53, v53
    v_exp_f32 v54, v54
    v_exp_f32 v55, v55
    v_exp_f32 v56, v56
    v_exp_f32 v57, v57
    v_smfmac_f32_32x32x32_bf16 v[184:199], v[28:31], v[48:55], v158
    v_exp_f32 v58, v58
    v_exp_f32 v59, v59
    v_exp_f32 v60, v60
    v_exp_f32 v61, v61
    v_exp_f32 v62, v62
    v_exp_f32 v63, v63
    v_exp_f32 v32, v32
    v_exp_f32 v33, v33
    v_smfmac_f32_32x32x32_bf16 v[184:199], v[20:23], v[56:63], v158
    s_cmp_eq_u32 s8, s0
    s_cbranch_scc1 gated_mix__softmax_full_mha__softmax_full_mha__prompt_kernel_late6
gated_mix__softmax_full_mha__softmax_full_mha__prompt_kernel_late6_back:
    s_cmp_eq_u32 s8, 3
    s_cbranch_scc1 gated_mix__softmax_full_mha__softmax_full_mha__prompt_kernel_extra
gated_mix__softmax_full_mha__softmax_full_mha__prompt_kernel_extra_back:
    v_exp_f32 v34, v34
    v_exp_f32 v35, v35
    v_exp_f32 v36, v36
    v_mfma_f32_32x32x16_bf16 v[48:63], v[16:19], v[204:207], 4.0
    ds_read_b128 v[16:19], v159 offset:7168
    ds_read_b128 v[20:23], v160 offset:6656
    ds_read_b128 v[28:31], v160 offset:7168
    v_exp_f32 v37, v37
    v_exp_f32 v38, v38
    v_exp_f32 v39, v39
    v_exp_f32 v40, v40
    v_exp_f32 v41, v41
    v_smfmac_f32_32x32x32_bf16 v[168:183], v[24:27], v[32:39], v158
    v_exp_f32 v42, v42
    v_exp_f32 v43, v43
    v_exp_f32 v44, v44
    v_exp_f32 v45, v45
    v_exp_f32 v46, v46
    v_exp_f32 v47, v47
    v_exp_f32 v48, v48
    v_exp_f32 v49, v49
    s_waitcnt lgkmcnt(0)
    v_smfmac_f32_32x32x32_bf16 v[168:183], v[20:23], v[40:47], v158
    s_setprio 1
    v_exp_f32 v50, v50
    v_exp_f32 v51, v51
    v_exp_f32 v52, v52
    v_mfma_f32_32x32x16_bf16 v[32:47], v[16:19], v[200:203], 4.0
    v_exp_f32 v53, v53
    v_exp_f32 v54, v54
    v_exp_f32 v55, v55
    v_exp_f32 v56, v56
    v_exp_f32 v57, v57
    v_smfmac_f32_32x32x32_bf16 v[184:199], v[24:27], v[48:55], v158
    s_setprio 0
    v_exp_f32 v58, v58
    v_exp_f32 v59, v59
    v_exp_f32 v60, v60
    v_exp_f32 v61, v61
    v_exp_f32 v62, v62
    v_exp_f32 v63, v63
    v_exp_f32 v32, v32
    v_exp_f32 v33, v33
    v_smfmac_f32_32x32x32_bf16 v[184:199], v[20:23], v[56:63], v158
    v_exp_f32 v34, v34
    v_exp_f32 v35, v35
    v_exp_f32 v36, v36
    v_mfma_f32_32x32x16_bf16 v[48:63], v[16:19], v[204:207], 4.0
    s_waitcnt vmcnt(4)
    s_barrier
    s_setprio 3
    ds_read_b128 v[20:23], v160 offset:7680
    v_add_u32 v159, s7, v155
    v_mad_u32_u24 v160, v157, s7, v156
    s_add_u32 s7, s7, 32768
    s_and_b32 s7, s7, 0x1ffff
    ds_read_b128 v[16:19], v159 offset:0
    ds_read_b128 v[24:27], v160 offset:0
    v_exp_f32 v37, v37
    v_exp_f32 v38, v38
    v_exp_f32 v39, v39
    v_exp_f32 v40, v40
    v_exp_f32 v41, v41
    v_smfmac_f32_32x32x32_bf16 v[168:183], v[28:31], v[32:39], v158
    v_exp_f32 v42, v42
    v_exp_f32 v43, v43
    v_exp_f32 v44, v44
    v_exp_f32 v45, v45
    v_exp_f32 v46, v46
    v_exp_f32 v47, v47
    v_exp_f32 v48, v48
    v_exp_f32 v49, v49
    s_waitcnt lgkmcnt(0)
    v_smfmac_f32_32x32x32_bf16 v[168:183], v[20:23], v[40:47], v158
    v_exp_f32 v50, v50
    v_exp_f32 v51, v51
    v_exp_f32 v52, v52
    v_mfma_f32_32x32x16_bf16 v[32:47], v[16:19], v[200:203], 4.0
    s_cmp_eq_u32 s8, s23
    s_cbranch_scc1 gated_mix__softmax_full_mha__softmax_full_mha__prompt_kernel_add2
gated_mix__softmax_full_mha__softmax_full_mha__prompt_kernel_add2_back:
    v_exp_f32 v53, v53
    v_exp_f32 v54, v54
    v_exp_f32 v55, v55
    v_exp_f32 v56, v56
    v_exp_f32 v57, v57
    v_smfmac_f32_32x32x32_bf16 v[184:199], v[28:31], v[48:55], v158
    v_exp_f32 v58, v58
    v_exp_f32 v59, v59
    v_exp_f32 v60, v60
    v_exp_f32 v61, v61
    v_exp_f32 v62, v62
    v_exp_f32 v63, v63
    v_exp_f32 v32, v32
    v_exp_f32 v33, v33
    v_smfmac_f32_32x32x32_bf16 v[184:199], v[20:23], v[56:63], v158
    s_sub_u32 s8, s8, 1
    s_cmp_lg_u32 s8, 0
    s_cbranch_scc1 gated_mix__softmax_full_mha__softmax_full_mha__prompt_kernel_mid

.p2align 3
    s_mov_b32 m0, s6
    s_add_u32 s57, s4, s5

    s_add_u32 s5, s5, 32768
    s_and_b32 s5, s5, 0x3ffff
    s_lshl_b32 s61, s53, 15
    s_cmp_eq_u32 s5, s61
    s_cselect_b32 s61, 32768, 0
    s_add_u32 s5, s5, s61
    s_and_b32 s5, s5, 0x3ffff

    s_add_u32 s6, s6, 32768
    s_and_b32 s6, s6, 0x1ffff

    v_exp_f32 v34, v34
    v_exp_f32 v35, v35
    v_exp_f32 v36, v36
    v_mfma_f32_32x32x16_bf16 v[48:63], v[16:19], v[204:207], 4.0
    ds_read_b128 v[16:19], v159 offset:1024
    ds_read_b128 v[20:23], v160 offset:512
    ds_read_b128 v[28:31], v160 offset:1024
    buffer_load_dwordx4 v1, s[32:35], s57 offen offset:0 sc1 lds
    buffer_load_dword v162, v164, s[32:35], s20 offen offset:0 sc1
    v_exp_f32 v37, v37
    v_exp_f32 v38, v38
    v_exp_f32 v39, v39
    v_exp_f32 v40, v40
    v_exp_f32 v41, v41
    v_smfmac_f32_32x32x32_bf16 v[168:183], v[24:27], v[32:39], v158
    v_exp_f32 v42, v42
    v_exp_f32 v43, v43
    v_exp_f32 v44, v44
    v_exp_f32 v45, v45
    v_exp_f32 v46, v46
    v_exp_f32 v47, v47
    v_exp_f32 v48, v48
    v_exp_f32 v49, v49
    s_waitcnt lgkmcnt(0)
    v_smfmac_f32_32x32x32_bf16 v[168:183], v[20:23], v[40:47], v158
    v_exp_f32 v50, v50
    v_exp_f32 v51, v51
    v_exp_f32 v52, v52
    v_mfma_f32_32x32x16_bf16 v[32:47], v[16:19], v[200:203], 4.0
    buffer_load_dwordx4 v1, s[32:35], s57 offen offset:1024 sc1 lds
    buffer_load_dword v163, v164, s[32:35], s20 offen offset:512 sc1
    s_add_u32 s63, s14, 0
    s_and_b32 s63, s63, 0x7fff
    s_add_u32 s63, s63, s13
    buffer_load_dwordx4 v[64:67], v1, s[32:35], s63 offen offset:0
    v_exp_f32 v53, v53
    v_exp_f32 v54, v54
    v_exp_f32 v55, v55
    v_exp_f32 v56, v56
    v_exp_f32 v57, v57
    v_smfmac_f32_32x32x32_bf16 v[184:199], v[24:27], v[48:55], v158
    v_exp_f32 v58, v58
    v_exp_f32 v59, v59
    v_exp_f32 v60, v60
    v_exp_f32 v61, v61
    v_exp_f32 v62, v62
    v_exp_f32 v63, v63
    v_exp_f32 v32, v32
    v_exp_f32 v33, v33
    v_smfmac_f32_32x32x32_bf16 v[184:199], v[20:23], v[56:63], v158
    v_exp_f32 v34, v34
    v_exp_f32 v35, v35
    v_exp_f32 v36, v36
    v_mfma_f32_32x32x16_bf16 v[48:63], v[16:19], v[204:207], 4.0
    ds_read_b128 v[16:19], v159 offset:2048
    ds_read_b128 v[20:23], v160 offset:1536
    ds_read_b128 v[24:27], v160 offset:2048
    buffer_load_dwordx4 v1, s[32:35], s57 offen offset:2048 sc1 lds
    buffer_load_dwordx4 v[68:71], v1, s[32:35], s63 offen offset:1024
    v_exp_f32 v37, v37
    v_exp_f32 v38, v38
    v_exp_f32 v39, v39
    v_exp_f32 v40, v40
    v_exp_f32 v41, v41
    v_smfmac_f32_32x32x32_bf16 v[168:183], v[28:31], v[32:39], v158
    v_exp_f32 v42, v42
    v_exp_f32 v43, v43
    v_exp_f32 v44, v44
    v_exp_f32 v45, v45
    v_exp_f32 v46, v46
    v_exp_f32 v47, v47
    v_exp_f32 v48, v48
    v_exp_f32 v49, v49
    s_waitcnt lgkmcnt(0)
    v_smfmac_f32_32x32x32_bf16 v[168:183], v[20:23], v[40:47], v158
    v_exp_f32 v50, v50
    v_exp_f32 v51, v51
    v_exp_f32 v52, v52
    v_mfma_f32_32x32x16_bf16 v[32:47], v[16:19], v[200:203], 4.0
    buffer_load_dwordx4 v1, s[32:35], s57 offen offset:3072 sc1 lds
    buffer_load_dwordx4 v[72:75], v1, s[32:35], s63 offen offset:2048
    buffer_load_dwordx4 v[76:79], v1, s[32:35], s63 offen offset:3072
    v_exp_f32 v53, v53
    v_exp_f32 v54, v54
    v_exp_f32 v55, v55
    v_exp_f32 v56, v56
    v_exp_f32 v57, v57
    v_smfmac_f32_32x32x32_bf16 v[184:199], v[28:31], v[48:55], v158
    v_exp_f32 v58, v58
    v_exp_f32 v59, v59
    v_exp_f32 v60, v60
    v_exp_f32 v61, v61
    v_exp_f32 v62, v62
    v_exp_f32 v63, v63
    v_exp_f32 v32, v32
    v_exp_f32 v33, v33
    v_smfmac_f32_32x32x32_bf16 v[184:199], v[20:23], v[56:63], v158
    v_exp_f32 v34, v34
    v_exp_f32 v35, v35
    v_exp_f32 v36, v36
    v_mfma_f32_32x32x16_bf16 v[48:63], v[16:19], v[204:207], 4.0
    ds_read_b128 v[16:19], v159 offset:3072
    ds_read_b128 v[20:23], v160 offset:2560
    ds_read_b128 v[28:31], v160 offset:3072
    s_add_u32 s63, s14, 4096
    s_and_b32 s63, s63, 0x7fff
    s_add_u32 s63, s63, s13
    buffer_load_dwordx4 v[80:83], v1, s[32:35], s63 offen offset:0
    v_exp_f32 v37, v37
    v_exp_f32 v38, v38
    v_exp_f32 v39, v39
    v_exp_f32 v40, v40
    v_exp_f32 v41, v41
    v_smfmac_f32_32x32x32_bf16 v[168:183], v[24:27], v[32:39], v158
    v_exp_f32 v42, v42
    v_exp_f32 v43, v43
    v_exp_f32 v44, v44
    v_exp_f32 v45, v45
    v_exp_f32 v46, v46
    v_exp_f32 v47, v47
    v_exp_f32 v48, v48
    v_exp_f32 v49, v49
    s_waitcnt lgkmcnt(0)
    v_smfmac_f32_32x32x32_bf16 v[168:183], v[20:23], v[40:47], v158
    v_exp_f32 v50, v50
    v_exp_f32 v51, v51
    v_exp_f32 v52, v52
    v_mfma_f32_32x32x16_bf16 v[32:47], v[16:19], v[200:203], 4.0
    buffer_load_dwordx4 v[84:87], v1, s[32:35], s63 offen offset:1024
    buffer_load_dwordx4 v[88:91], v1, s[32:35], s63 offen offset:2048
    v_exp_f32 v53, v53
    v_exp_f32 v54, v54
    v_exp_f32 v55, v55
    v_exp_f32 v56, v56
    v_exp_f32 v57, v57
    v_smfmac_f32_32x32x32_bf16 v[184:199], v[24:27], v[48:55], v158
    v_exp_f32 v58, v58
    v_exp_f32 v59, v59
    v_exp_f32 v60, v60
    v_exp_f32 v61, v61
    v_exp_f32 v62, v62
    v_exp_f32 v63, v63
    v_exp_f32 v32, v32
    v_exp_f32 v33, v33
    v_smfmac_f32_32x32x32_bf16 v[184:199], v[20:23], v[56:63], v158
    v_exp_f32 v34, v34
    v_exp_f32 v35, v35
    v_exp_f32 v36, v36
    v_mfma_f32_32x32x16_bf16 v[48:63], v[16:19], v[204:207], 4.0
    ds_read_b128 v[16:19], v159 offset:4096
    ds_read_b128 v[20:23], v160 offset:3584
    ds_read_b128 v[24:27], v160 offset:4096
    buffer_load_dwordx4 v[92:95], v1, s[32:35], s63 offen offset:3072
    v_exp_f32 v37, v37
    v_exp_f32 v38, v38
    v_exp_f32 v39, v39
    v_exp_f32 v40, v40
    v_exp_f32 v41, v41
    v_smfmac_f32_32x32x32_bf16 v[168:183], v[28:31], v[32:39], v158
    v_exp_f32 v42, v42
    v_exp_f32 v43, v43
    v_exp_f32 v44, v44
    v_exp_f32 v45, v45
    v_exp_f32 v46, v46
    v_exp_f32 v47, v47
    v_exp_f32 v48, v48
    v_exp_f32 v49, v49
    s_waitcnt lgkmcnt(0)
    v_smfmac_f32_32x32x32_bf16 v[168:183], v[20:23], v[40:47], v158
    v_exp_f32 v50, v50
    v_exp_f32 v51, v51
    v_exp_f32 v52, v52
    v_mfma_f32_32x32x16_bf16 v[32:47], v[16:19], v[200:203], 4.0
    s_add_u32 s63, s14, 8192
    s_and_b32 s63, s63, 0x7fff
    s_add_u32 s63, s63, s13
    buffer_load_dwordx4 v[96:99], v1, s[32:35], s63 offen offset:0
    buffer_load_dwordx4 v[100:103], v1, s[32:35], s63 offen offset:1024
    v_exp_f32 v53, v53
    v_exp_f32 v54, v54
    v_exp_f32 v55, v55
    v_exp_f32 v56, v56
    v_exp_f32 v57, v57
    v_smfmac_f32_32x32x32_bf16 v[184:199], v[28:31], v[48:55], v158
    v_exp_f32 v58, v58
    v_exp_f32 v59, v59
    v_exp_f32 v60, v60
    v_exp_f32 v61, v61
    v_exp_f32 v62, v62
    v_exp_f32 v63, v63
    v_exp_f32 v32, v32
    v_exp_f32 v33, v33
    v_smfmac_f32_32x32x32_bf16 v[184:199], v[20:23], v[56:63], v158
    v_exp_f32 v34, v34
    v_exp_f32 v35, v35
    v_exp_f32 v36, v36
    v_mfma_f32_32x32x16_bf16 v[48:63], v[16:19], v[204:207], 4.0
    ds_read_b128 v[16:19], v159 offset:5120
    ds_read_b128 v[20:23], v160 offset:4608
    ds_read_b128 v[28:31], v160 offset:5120
    buffer_load_dwordx4 v[104:107], v1, s[32:35], s63 offen offset:2048
    v_exp_f32 v37, v37
    v_exp_f32 v38, v38
    v_exp_f32 v39, v39
    v_exp_f32 v40, v40
    v_exp_f32 v41, v41
    v_smfmac_f32_32x32x32_bf16 v[168:183], v[24:27], v[32:39], v158
    v_exp_f32 v42, v42
    v_exp_f32 v43, v43
    v_exp_f32 v44, v44
    v_exp_f32 v45, v45
    v_exp_f32 v46, v46
    v_exp_f32 v47, v47
    v_exp_f32 v48, v48
    v_exp_f32 v49, v49
    s_waitcnt lgkmcnt(0)
    v_smfmac_f32_32x32x32_bf16 v[168:183], v[20:23], v[40:47], v158
    v_exp_f32 v50, v50
    v_exp_f32 v51, v51
    v_exp_f32 v52, v52
    v_mfma_f32_32x32x16_bf16 v[32:47], v[16:19], v[200:203], 4.0
    buffer_load_dwordx4 v[108:111], v1, s[32:35], s63 offen offset:3072
    s_add_u32 s63, s14, 12288
    s_and_b32 s63, s63, 0x7fff
    s_add_u32 s63, s63, s13
    buffer_load_dwordx4 v[112:115], v1, s[32:35], s63 offen offset:0
    v_exp_f32 v53, v53
    v_exp_f32 v54, v54
    v_exp_f32 v55, v55
    v_exp_f32 v56, v56
    v_exp_f32 v57, v57
    v_smfmac_f32_32x32x32_bf16 v[184:199], v[24:27], v[48:55], v158
    v_exp_f32 v58, v58
    v_exp_f32 v59, v59
    v_exp_f32 v60, v60
    v_exp_f32 v61, v61
    v_exp_f32 v62, v62
    v_exp_f32 v63, v63
    v_exp_f32 v32, v32
    v_exp_f32 v33, v33
    v_smfmac_f32_32x32x32_bf16 v[184:199], v[20:23], v[56:63], v158
    v_exp_f32 v34, v34
    v_exp_f32 v35, v35
    v_exp_f32 v36, v36
    v_mfma_f32_32x32x16_bf16 v[48:63], v[16:19], v[204:207], 4.0
    ds_read_b128 v[16:19], v159 offset:6144
    ds_read_b128 v[20:23], v160 offset:5632
    ds_read_b128 v[24:27], v160 offset:6144
    buffer_load_dwordx4 v[116:119], v1, s[32:35], s63 offen offset:1024
    v_exp_f32 v37, v37
    v_exp_f32 v38, v38
    v_exp_f32 v39, v39
    v_exp_f32 v40, v40
    v_exp_f32 v41, v41
    v_smfmac_f32_32x32x32_bf16 v[168:183], v[28:31], v[32:39], v158
    v_exp_f32 v42, v42
    v_exp_f32 v43, v43
    v_exp_f32 v44, v44
    v_exp_f32 v45, v45
    v_exp_f32 v46, v46
    v_exp_f32 v47, v47
    v_exp_f32 v48, v48
    v_exp_f32 v49, v49
    s_waitcnt lgkmcnt(0)
    v_smfmac_f32_32x32x32_bf16 v[168:183], v[20:23], v[40:47], v158
    s_setprio 2
    v_exp_f32 v50, v50
    v_exp_f32 v51, v51
    v_exp_f32 v52, v52
    v_mfma_f32_32x32x16_bf16 v[32:47], v[16:19], v[200:203], 4.0
    buffer_load_dwordx4 v[120:123], v1, s[32:35], s63 offen offset:2048
    buffer_load_dwordx4 v[124:127], v1, s[32:35], s63 offen offset:3072
    v_exp_f32 v53, v53
    v_exp_f32 v54, v54
    v_exp_f32 v55, v55
    v_exp_f32 v56, v56
    v_exp_f32 v57, v57
    v_smfmac_f32_32x32x32_bf16 v[184:199], v[28:31], v[48:55], v158
    v_exp_f32 v58, v58
    v_exp_f32 v59, v59
    v_exp_f32 v60, v60
    v_exp_f32 v61, v61
    v_exp_f32 v62, v62
    v_exp_f32 v63, v63
    v_exp_f32 v32, v32
    v_exp_f32 v33, v33
    v_smfmac_f32_32x32x32_bf16 v[184:199], v[20:23], v[56:63], v158
    v_exp_f32 v34, v34
    v_exp_f32 v35, v35
    v_exp_f32 v36, v36
    v_mfma_f32_32x32x16_bf16 v[48:63], v[16:19], v[204:207], 4.0
    ds_read_b128 v[16:19], v159 offset:7168
    ds_read_b128 v[20:23], v160 offset:6656
    ds_read_b128 v[28:31], v160 offset:7168
    s_add_u32 s63, s14, 16384
    s_and_b32 s63, s63, 0x7fff
    s_add_u32 s63, s63, s13
    buffer_load_dwordx4 v[128:131], v1, s[32:35], s63 offen offset:0
    v_exp_f32 v37, v37
    v_exp_f32 v38, v38
    v_exp_f32 v39, v39
    v_exp_f32 v40, v40
    v_exp_f32 v41, v41
    v_smfmac_f32_32x32x32_bf16 v[168:183], v[24:27], v[32:39], v158
    v_exp_f32 v42, v42
    v_exp_f32 v43, v43
    v_exp_f32 v44, v44
    v_exp_f32 v45, v45
    v_exp_f32 v46, v46
    v_exp_f32 v47, v47
    v_exp_f32 v48, v48
    v_exp_f32 v49, v49
    s_waitcnt lgkmcnt(0)
    v_smfmac_f32_32x32x32_bf16 v[168:183], v[20:23], v[40:47], v158
    s_setprio 1
    v_exp_f32 v50, v50
    v_exp_f32 v51, v51
    v_exp_f32 v52, v52
    v_mfma_f32_32x32x16_bf16 v[32:47], v[16:19], v[200:203], 4.0
    buffer_load_dwordx4 v[132:135], v1, s[32:35], s63 offen offset:1024
    buffer_load_dwordx4 v[136:139], v1, s[32:35], s63 offen offset:2048
    v_exp_f32 v53, v53
    v_exp_f32 v54, v54
    v_exp_f32 v55, v55
    v_exp_f32 v56, v56
    v_exp_f32 v57, v57
    v_smfmac_f32_32x32x32_bf16 v[184:199], v[24:27], v[48:55], v158
    s_setprio 0
    v_exp_f32 v58, v58
    v_exp_f32 v59, v59
    v_exp_f32 v60, v60
    v_exp_f32 v61, v61
    v_exp_f32 v62, v62
    v_exp_f32 v63, v63
    v_exp_f32 v32, v32
    v_exp_f32 v33, v33
    v_smfmac_f32_32x32x32_bf16 v[184:199], v[20:23], v[56:63], v158
    v_exp_f32 v34, v34
    v_exp_f32 v35, v35
    v_exp_f32 v36, v36
    v_mfma_f32_32x32x16_bf16 v[48:63], v[16:19], v[204:207], 4.0
    s_waitcnt vmcnt(25)
    s_barrier
    s_setprio 3
    ds_read_b128 v[20:23], v160 offset:7680
    v_add_u32 v159, s7, v155
    v_mad_u32_u24 v160, v157, s7, v156
    s_add_u32 s7, s7, 32768
    s_and_b32 s7, s7, 0x1ffff
    ds_read_b128 v[16:19], v159 offset:0
    ds_read_b128 v[24:27], v160 offset:0
    buffer_load_dwordx4 v[140:143], v1, s[32:35], s63 offen offset:3072
    v_exp_f32 v37, v37
    v_exp_f32 v38, v38
    v_exp_f32 v39, v39
    v_exp_f32 v40, v40
    v_exp_f32 v41, v41
    v_smfmac_f32_32x32x32_bf16 v[168:183], v[28:31], v[32:39], v158
    v_exp_f32 v42, v42
    v_exp_f32 v43, v43
    v_exp_f32 v44, v44
    v_exp_f32 v45, v45
    v_exp_f32 v46, v46
    v_exp_f32 v47, v47
    v_exp_f32 v48, v48
    v_exp_f32 v49, v49
    s_waitcnt lgkmcnt(0)
    v_smfmac_f32_32x32x32_bf16 v[168:183], v[20:23], v[40:47], v158
    v_exp_f32 v50, v50
    v_exp_f32 v51, v51
    v_exp_f32 v52, v52
    v_mfma_f32_32x32x16_bf16 v[32:47], v[16:19], v[200:203], 4.0
    s_add_u32 s63, s14, 20480
    s_and_b32 s63, s63, 0x7fff
    s_add_u32 s63, s63, s13
    buffer_load_dwordx4 v[144:147], v1, s[32:35], s63 offen offset:0
    buffer_load_dwordx4 v[148:151], v1, s[32:35], s63 offen offset:1024
    v_exp_f32 v53, v53
    v_exp_f32 v54, v54
    v_exp_f32 v55, v55
    v_exp_f32 v56, v56
    v_exp_f32 v57, v57
    v_smfmac_f32_32x32x32_bf16 v[184:199], v[28:31], v[48:55], v158
    v_exp_f32 v58, v58
    v_exp_f32 v59, v59
    v_exp_f32 v60, v60
    v_exp_f32 v61, v61
    v_exp_f32 v62, v62
    v_exp_f32 v63, v63
    v_exp_f32 v32, v32
    v_exp_f32 v33, v33
    v_smfmac_f32_32x32x32_bf16 v[184:199], v[20:23], v[56:63], v158
.p2align 3
    s_mov_b32 m0, s6
    s_add_u32 s57, s4, s5

    s_add_u32 s5, s5, 32768
    s_and_b32 s5, s5, 0x3ffff
    s_lshl_b32 s61, s53, 15
    s_cmp_eq_u32 s5, s61
    s_cselect_b32 s61, 32768, 0
    s_add_u32 s5, s5, s61
    s_and_b32 s5, s5, 0x3ffff

    s_add_u32 s6, s6, 32768
    s_and_b32 s6, s6, 0x1ffff

    v_exp_f32 v34, v34
    v_exp_f32 v35, v35
    v_exp_f32 v36, v36
    v_mfma_f32_32x32x16_bf16 v[48:63], v[16:19], v[204:207], 4.0
    ds_read_b128 v[16:19], v159 offset:1024
    ds_read_b128 v[20:23], v160 offset:512
    ds_read_b128 v[28:31], v160 offset:1024
    buffer_load_dwordx4 v1, s[32:35], s57 offen offset:0 sc1 lds
    buffer_load_dwordx4 v[208:211], v1, s[32:35], s63 offen offset:2048
    v_exp_f32 v37, v37
    v_exp_f32 v38, v38
    v_exp_f32 v39, v39
    v_exp_f32 v40, v40
    v_exp_f32 v41, v41
    v_smfmac_f32_32x32x32_bf16 v[168:183], v[24:27], v[32:39], v158
    v_exp_f32 v42, v42
    v_exp_f32 v43, v43
    v_exp_f32 v44, v44
    v_exp_f32 v45, v45
    v_exp_f32 v46, v46
    v_exp_f32 v47, v47
    v_exp_f32 v48, v48
    v_exp_f32 v49, v49
    s_waitcnt lgkmcnt(0)
    v_smfmac_f32_32x32x32_bf16 v[168:183], v[20:23], v[40:47], v158
    v_exp_f32 v50, v50
    v_exp_f32 v51, v51
    v_exp_f32 v52, v52
    v_mfma_f32_32x32x16_bf16 v[32:47], v[16:19], v[200:203], 4.0
    buffer_load_dwordx4 v1, s[32:35], s57 offen offset:1024 sc1 lds
    buffer_load_dwordx4 v[212:215], v1, s[32:35], s63 offen offset:3072
    s_add_u32 s63, s14, 24576
    s_and_b32 s63, s63, 0x7fff
    s_add_u32 s63, s63, s13
    buffer_load_dwordx4 v[216:219], v1, s[32:35], s63 offen offset:0
    v_exp_f32 v53, v53
    v_exp_f32 v54, v54
    v_exp_f32 v55, v55
    v_exp_f32 v56, v56
    v_exp_f32 v57, v57
    v_smfmac_f32_32x32x32_bf16 v[184:199], v[24:27], v[48:55], v158
    v_exp_f32 v58, v58
    v_exp_f32 v59, v59
    v_exp_f32 v60, v60
    v_exp_f32 v61, v61
    v_exp_f32 v62, v62
    v_exp_f32 v63, v63
    v_exp_f32 v32, v32
    v_exp_f32 v33, v33
    v_smfmac_f32_32x32x32_bf16 v[184:199], v[20:23], v[56:63], v158
    v_exp_f32 v34, v34
    v_exp_f32 v35, v35
    v_exp_f32 v36, v36
    v_mfma_f32_32x32x16_bf16 v[48:63], v[16:19], v[204:207], 4.0
    ds_read_b128 v[16:19], v159 offset:2048
    ds_read_b128 v[20:23], v160 offset:1536
    ds_read_b128 v[24:27], v160 offset:2048
    buffer_load_dwordx4 v1, s[32:35], s57 offen offset:2048 sc1 lds
    buffer_load_dwordx4 v[220:223], v1, s[32:35], s63 offen offset:1024
    v_exp_f32 v37, v37
    v_exp_f32 v38, v38
    v_exp_f32 v39, v39
    v_exp_f32 v40, v40
    v_exp_f32 v41, v41
    v_smfmac_f32_32x32x32_bf16 v[168:183], v[28:31], v[32:39], v158
    v_exp_f32 v42, v42
    v_exp_f32 v43, v43
    v_exp_f32 v44, v44
    v_exp_f32 v45, v45
    v_exp_f32 v46, v46
    v_exp_f32 v47, v47
    v_exp_f32 v48, v48
    v_exp_f32 v49, v49
    s_waitcnt lgkmcnt(0)
    v_smfmac_f32_32x32x32_bf16 v[168:183], v[20:23], v[40:47], v158
    v_exp_f32 v50, v50
    v_exp_f32 v51, v51
    v_exp_f32 v52, v52
    v_mfma_f32_32x32x16_bf16 v[32:47], v[16:19], v[200:203], 4.0
    buffer_load_dwordx4 v1, s[32:35], s57 offen offset:3072 sc1 lds
    buffer_load_dwordx4 v[224:227], v1, s[32:35], s63 offen offset:2048
    buffer_load_dwordx4 v[228:231], v1, s[32:35], s63 offen offset:3072
    v_exp_f32 v53, v53
    v_exp_f32 v54, v54
    v_exp_f32 v55, v55
    v_exp_f32 v56, v56
    v_exp_f32 v57, v57
    v_smfmac_f32_32x32x32_bf16 v[184:199], v[28:31], v[48:55], v158
    v_exp_f32 v58, v58
    v_exp_f32 v59, v59
    v_exp_f32 v60, v60
    v_exp_f32 v61, v61
    v_exp_f32 v62, v62
    v_exp_f32 v63, v63
    v_exp_f32 v32, v32
    v_exp_f32 v33, v33
    v_smfmac_f32_32x32x32_bf16 v[184:199], v[20:23], v[56:63], v158
    v_exp_f32 v34, v34
    v_exp_f32 v35, v35
    v_exp_f32 v36, v36
    v_mfma_f32_32x32x16_bf16 v[48:63], v[16:19], v[204:207], 4.0
    ds_read_b128 v[16:19], v159 offset:3072
    ds_read_b128 v[20:23], v160 offset:2560
    ds_read_b128 v[28:31], v160 offset:3072
    s_add_u32 s63, s14, 28672
    s_and_b32 s63, s63, 0x7fff
    s_add_u32 s63, s63, s13
    buffer_load_dwordx4 v[232:235], v1, s[32:35], s63 offen offset:0
    v_exp_f32 v37, v37
    v_exp_f32 v38, v38
    v_exp_f32 v39, v39
    v_exp_f32 v40, v40
    v_exp_f32 v41, v41
    v_smfmac_f32_32x32x32_bf16 v[168:183], v[24:27], v[32:39], v158
    v_exp_f32 v42, v42
    v_exp_f32 v43, v43
    v_exp_f32 v44, v44
    v_exp_f32 v45, v45
    v_exp_f32 v46, v46
    v_exp_f32 v47, v47
    v_exp_f32 v48, v48
    v_exp_f32 v49, v49
    s_waitcnt lgkmcnt(0)
    v_smfmac_f32_32x32x32_bf16 v[168:183], v[20:23], v[40:47], v158
    v_exp_f32 v50, v50
    v_exp_f32 v51, v51
    v_exp_f32 v52, v52
    v_mfma_f32_32x32x16_bf16 v[32:47], v[16:19], v[200:203], 4.0
    buffer_load_dwordx4 v[236:239], v1, s[32:35], s63 offen offset:1024
    buffer_load_dwordx4 v[240:243], v1, s[32:35], s63 offen offset:2048
    v_exp_f32 v53, v53
    v_exp_f32 v54, v54
    v_exp_f32 v55, v55
    v_exp_f32 v56, v56
    v_exp_f32 v57, v57
    v_smfmac_f32_32x32x32_bf16 v[184:199], v[24:27], v[48:55], v158
    v_exp_f32 v58, v58
    v_exp_f32 v59, v59
    v_exp_f32 v60, v60
    v_exp_f32 v61, v61
    v_exp_f32 v62, v62
    v_exp_f32 v63, v63
    v_exp_f32 v32, v32
    v_exp_f32 v33, v33
    v_smfmac_f32_32x32x32_bf16 v[184:199], v[20:23], v[56:63], v158
    v_exp_f32 v34, v34
    v_exp_f32 v35, v35
    v_exp_f32 v36, v36
    v_mfma_f32_32x32x16_bf16 v[48:63], v[16:19], v[204:207], 4.0
    ds_read_b128 v[16:19], v159 offset:4096
    ds_read_b128 v[20:23], v160 offset:3584
    ds_read_b128 v[24:27], v160 offset:4096
    buffer_load_dwordx4 v[244:247], v1, s[32:35], s63 offen offset:3072
    v_exp_f32 v37, v37
    v_exp_f32 v38, v38
    v_exp_f32 v39, v39
    v_exp_f32 v40, v40
    v_exp_f32 v41, v41
    v_smfmac_f32_32x32x32_bf16 v[168:183], v[28:31], v[32:39], v158
    v_exp_f32 v42, v42
    v_exp_f32 v43, v43
    v_exp_f32 v44, v44
    v_exp_f32 v45, v45
    v_exp_f32 v46, v46
    v_exp_f32 v47, v47
    v_exp_f32 v48, v48
    v_exp_f32 v49, v49
    s_waitcnt lgkmcnt(0)
    v_smfmac_f32_32x32x32_bf16 v[168:183], v[20:23], v[40:47], v158
    v_exp_f32 v50, v50
    v_exp_f32 v51, v51
    v_exp_f32 v52, v52
    v_mfma_f32_32x32x16_bf16 v[32:47], v[16:19], v[200:203], 4.0
    v_exp_f32 v53, v53
    v_exp_f32 v54, v54
    v_exp_f32 v55, v55
    v_exp_f32 v56, v56
    v_exp_f32 v57, v57
    v_smfmac_f32_32x32x32_bf16 v[184:199], v[28:31], v[48:55], v158
    v_exp_f32 v58, v58
    v_exp_f32 v59, v59
    v_exp_f32 v60, v60
    v_exp_f32 v61, v61
    v_exp_f32 v62, v62
    v_exp_f32 v63, v63
    v_exp_f32 v32, v32
    v_exp_f32 v33, v33
    v_smfmac_f32_32x32x32_bf16 v[184:199], v[20:23], v[56:63], v158
    v_exp_f32 v34, v34
    v_exp_f32 v35, v35
    v_exp_f32 v36, v36
    v_mfma_f32_32x32x16_bf16 v[48:63], v[16:19], v[204:207], 4.0
    ds_read_b128 v[16:19], v159 offset:5120
    ds_read_b128 v[20:23], v160 offset:4608
    ds_read_b128 v[28:31], v160 offset:5120
    v_exp_f32 v37, v37
    v_exp_f32 v38, v38
    v_exp_f32 v39, v39
    v_exp_f32 v40, v40
    v_exp_f32 v41, v41
    v_smfmac_f32_32x32x32_bf16 v[168:183], v[24:27], v[32:39], v158
    v_exp_f32 v42, v42
    v_exp_f32 v43, v43
    v_exp_f32 v44, v44
    v_exp_f32 v45, v45
    v_exp_f32 v46, v46
    v_exp_f32 v47, v47
    v_exp_f32 v48, v48
    v_exp_f32 v49, v49
    s_waitcnt lgkmcnt(0)
    v_smfmac_f32_32x32x32_bf16 v[168:183], v[20:23], v[40:47], v158
    v_exp_f32 v50, v50
    v_exp_f32 v51, v51
    v_exp_f32 v52, v52
    v_mfma_f32_32x32x16_bf16 v[32:47], v[16:19], v[200:203], 4.0
    v_exp_f32 v53, v53
    v_exp_f32 v54, v54
    v_exp_f32 v55, v55
    v_exp_f32 v56, v56
    v_exp_f32 v57, v57
    v_smfmac_f32_32x32x32_bf16 v[184:199], v[24:27], v[48:55], v158
    v_exp_f32 v58, v58
    v_exp_f32 v59, v59
    v_exp_f32 v60, v60
    v_exp_f32 v61, v61
    v_exp_f32 v62, v62
    v_exp_f32 v63, v63
    v_exp_f32 v32, v32
    v_exp_f32 v33, v33
    v_smfmac_f32_32x32x32_bf16 v[184:199], v[20:23], v[56:63], v158
    v_exp_f32 v34, v34
    v_exp_f32 v35, v35
    v_exp_f32 v36, v36
    v_mfma_f32_32x32x16_bf16 v[48:63], v[16:19], v[204:207], 4.0
    ds_read_b128 v[16:19], v159 offset:6144
    ds_read_b128 v[20:23], v160 offset:5632
    ds_read_b128 v[24:27], v160 offset:6144
    v_exp_f32 v37, v37
    v_exp_f32 v38, v38
    v_exp_f32 v39, v39
    v_exp_f32 v40, v40
    v_exp_f32 v41, v41
    v_smfmac_f32_32x32x32_bf16 v[168:183], v[28:31], v[32:39], v158
    v_exp_f32 v42, v42
    v_exp_f32 v43, v43
    v_exp_f32 v44, v44
    v_exp_f32 v45, v45
    v_exp_f32 v46, v46
    v_exp_f32 v47, v47
    v_exp_f32 v48, v48
    v_exp_f32 v49, v49
    s_waitcnt lgkmcnt(0)
    v_smfmac_f32_32x32x32_bf16 v[168:183], v[20:23], v[40:47], v158
    s_setprio 2
    v_exp_f32 v50, v50
    v_exp_f32 v51, v51
    v_exp_f32 v52, v52
    v_mfma_f32_32x32x16_bf16 v[32:47], v[16:19], v[200:203], 4.0
    v_exp_f32 v53, v53
    v_exp_f32 v54, v54
    v_exp_f32 v55, v55
    v_exp_f32 v56, v56
    v_exp_f32 v57, v57
    v_smfmac_f32_32x32x32_bf16 v[184:199], v[28:31], v[48:55], v158
    v_exp_f32 v58, v58
    v_exp_f32 v59, v59
    v_exp_f32 v60, v60
    v_exp_f32 v61, v61
    v_exp_f32 v62, v62
    v_exp_f32 v63, v63
    v_exp_f32 v32, v32
    v_exp_f32 v33, v33
    v_smfmac_f32_32x32x32_bf16 v[184:199], v[20:23], v[56:63], v158
    v_exp_f32 v34, v34
    v_exp_f32 v35, v35
    v_exp_f32 v36, v36
    v_mfma_f32_32x32x16_bf16 v[48:63], v[16:19], v[204:207], 4.0
    ds_read_b128 v[16:19], v159 offset:7168
    ds_read_b128 v[20:23], v160 offset:6656
    ds_read_b128 v[28:31], v160 offset:7168
    v_exp_f32 v37, v37
    v_exp_f32 v38, v38
    v_exp_f32 v39, v39
    v_exp_f32 v40, v40
    v_exp_f32 v41, v41
    v_smfmac_f32_32x32x32_bf16 v[168:183], v[24:27], v[32:39], v158
    v_exp_f32 v42, v42
    v_exp_f32 v43, v43
    v_exp_f32 v44, v44
    v_exp_f32 v45, v45
    v_exp_f32 v46, v46
    v_exp_f32 v47, v47
    v_exp_f32 v48, v48
    v_exp_f32 v49, v49
    s_waitcnt lgkmcnt(0)
    v_smfmac_f32_32x32x32_bf16 v[168:183], v[20:23], v[40:47], v158
    s_setprio 1
    v_exp_f32 v50, v50
    v_exp_f32 v51, v51
    v_exp_f32 v52, v52
    v_mfma_f32_32x32x16_bf16 v[32:47], v[16:19], v[200:203], 4.0
    v_exp_f32 v53, v53
    v_exp_f32 v54, v54
    v_exp_f32 v55, v55
    v_exp_f32 v56, v56
    v_exp_f32 v57, v57
    v_smfmac_f32_32x32x32_bf16 v[184:199], v[24:27], v[48:55], v158
    s_setprio 0
    v_exp_f32 v58, v58
    v_exp_f32 v59, v59
    v_exp_f32 v60, v60
    v_exp_f32 v61, v61
    v_exp_f32 v62, v62
    v_exp_f32 v63, v63
    v_exp_f32 v32, v32
    v_exp_f32 v33, v33
    v_smfmac_f32_32x32x32_bf16 v[184:199], v[20:23], v[56:63], v158
    v_exp_f32 v34, v34
    v_exp_f32 v35, v35
    v_exp_f32 v36, v36
    v_mfma_f32_32x32x16_bf16 v[48:63], v[16:19], v[204:207], 4.0
    ds_read_b128 v[20:23], v160 offset:7680
    s_waitcnt vmcnt(6) lgkmcnt(0)
    s_barrier
    s_setprio 2
    s_cmp_ge_u32 s3, 4
    s_cbranch_scc1 gated_mix__softmax_full_mha__softmax_full_mha__prompt_kernel_young
    s_setprio 3

gated_mix__softmax_full_mha__softmax_full_mha__prompt_kernel_young:
    v_add_u32 v159, s7, v155
    v_mad_u32_u24 v160, v157, s7, v156
    s_add_u32 s7, s7, 32768
    s_and_b32 s7, s7, 0x1ffff
    ds_read_b128 v[16:19], v159 offset:0
    ds_read_b128 v[24:27], v160 offset:0
    v_exp_f32 v37, v37
    v_exp_f32 v38, v38
    v_exp_f32 v39, v39
    v_exp_f32 v40, v40
    v_exp_f32 v41, v41
    v_smfmac_f32_32x32x32_bf16 v[168:183], v[28:31], v[32:39], v158
    v_exp_f32 v42, v42
    v_exp_f32 v43, v43
    v_exp_f32 v44, v44
    v_exp_f32 v45, v45
    v_exp_f32 v46, v46
    v_exp_f32 v47, v47
    v_exp_f32 v48, v48
    v_exp_f32 v49, v49
    s_waitcnt lgkmcnt(0)
    v_smfmac_f32_32x32x32_bf16 v[168:183], v[20:23], v[40:47], v158
    v_exp_f32 v50, v50
    v_exp_f32 v51, v51
    v_exp_f32 v52, v52
    v_mfma_f32_32x32x16_bf16 v[32:47], v[16:19], v[200:203], 4.0
    v_exp_f32 v53, v53
    v_exp_f32 v54, v54
    v_exp_f32 v55, v55
    v_exp_f32 v56, v56
    v_exp_f32 v57, v57
    v_smfmac_f32_32x32x32_bf16 v[184:199], v[28:31], v[48:55], v158
    v_exp_f32 v58, v58
    v_exp_f32 v59, v59
    v_exp_f32 v60, v60
    v_exp_f32 v61, v61
    v_exp_f32 v62, v62
    v_exp_f32 v63, v63
    v_exp_f32 v32, v32
    v_exp_f32 v33, v33
    v_smfmac_f32_32x32x32_bf16 v[184:199], v[20:23], v[56:63], v158
    s_mov_b32 s8, 2
.p2align 3
gated_mix__softmax_full_mha__softmax_full_mha__prompt_kernel_free:
    v_exp_f32 v34, v34
    v_exp_f32 v35, v35
    v_exp_f32 v36, v36
    v_mfma_f32_32x32x16_bf16 v[48:63], v[16:19], v[204:207], 4.0
    ds_read_b128 v[16:19], v159 offset:1024
    ds_read_b128 v[20:23], v160 offset:512
    ds_read_b128 v[28:31], v160 offset:1024
    v_exp_f32 v37, v37
    v_exp_f32 v38, v38
    v_exp_f32 v39, v39
    v_exp_f32 v40, v40
    v_exp_f32 v41, v41
    v_smfmac_f32_32x32x32_bf16 v[168:183], v[24:27], v[32:39], v158
    v_exp_f32 v42, v42
    v_exp_f32 v43, v43
    v_exp_f32 v44, v44
    v_exp_f32 v45, v45
    v_exp_f32 v46, v46
    v_exp_f32 v47, v47
    v_exp_f32 v48, v48
    v_exp_f32 v49, v49
    s_waitcnt lgkmcnt(0)
    v_smfmac_f32_32x32x32_bf16 v[168:183], v[20:23], v[40:47], v158
    v_exp_f32 v50, v50
    v_exp_f32 v51, v51
    v_exp_f32 v52, v52
    v_mfma_f32_32x32x16_bf16 v[32:47], v[16:19], v[200:203], 4.0
    v_exp_f32 v53, v53
    v_exp_f32 v54, v54
    v_exp_f32 v55, v55
    v_exp_f32 v56, v56
    v_exp_f32 v57, v57
    v_smfmac_f32_32x32x32_bf16 v[184:199], v[24:27], v[48:55], v158
    v_exp_f32 v58, v58
    v_exp_f32 v59, v59
    v_exp_f32 v60, v60
    v_exp_f32 v61, v61
    v_exp_f32 v62, v62
    v_exp_f32 v63, v63
    v_exp_f32 v32, v32
    v_exp_f32 v33, v33
    v_smfmac_f32_32x32x32_bf16 v[184:199], v[20:23], v[56:63], v158
    v_exp_f32 v34, v34
    v_exp_f32 v35, v35
    v_exp_f32 v36, v36
    v_mfma_f32_32x32x16_bf16 v[48:63], v[16:19], v[204:207], 4.0
    ds_read_b128 v[16:19], v159 offset:2048
    ds_read_b128 v[20:23], v160 offset:1536
    ds_read_b128 v[24:27], v160 offset:2048
    v_exp_f32 v37, v37
    v_exp_f32 v38, v38
    v_exp_f32 v39, v39
    v_exp_f32 v40, v40
    v_exp_f32 v41, v41
    v_smfmac_f32_32x32x32_bf16 v[168:183], v[28:31], v[32:39], v158
    v_exp_f32 v42, v42
    v_exp_f32 v43, v43
    v_exp_f32 v44, v44
    v_exp_f32 v45, v45
    v_exp_f32 v46, v46
    v_exp_f32 v47, v47
    v_exp_f32 v48, v48
    v_exp_f32 v49, v49
    s_waitcnt lgkmcnt(0)
    v_smfmac_f32_32x32x32_bf16 v[168:183], v[20:23], v[40:47], v158
    v_exp_f32 v50, v50
    v_exp_f32 v51, v51
    v_exp_f32 v52, v52
    v_mfma_f32_32x32x16_bf16 v[32:47], v[16:19], v[200:203], 4.0
    v_exp_f32 v53, v53
    v_exp_f32 v54, v54
    v_exp_f32 v55, v55
    v_exp_f32 v56, v56
    v_exp_f32 v57, v57
    v_smfmac_f32_32x32x32_bf16 v[184:199], v[28:31], v[48:55], v158
    v_exp_f32 v58, v58
    v_exp_f32 v59, v59
    v_exp_f32 v60, v60
    v_exp_f32 v61, v61
    v_exp_f32 v62, v62
    v_exp_f32 v63, v63
    v_exp_f32 v32, v32
    v_exp_f32 v33, v33
    v_smfmac_f32_32x32x32_bf16 v[184:199], v[20:23], v[56:63], v158
    v_exp_f32 v34, v34
    v_exp_f32 v35, v35
    v_exp_f32 v36, v36
    v_mfma_f32_32x32x16_bf16 v[48:63], v[16:19], v[204:207], 4.0
    ds_read_b128 v[16:19], v159 offset:3072
    ds_read_b128 v[20:23], v160 offset:2560
    ds_read_b128 v[28:31], v160 offset:3072
    v_exp_f32 v37, v37
    v_exp_f32 v38, v38
    v_exp_f32 v39, v39
    v_exp_f32 v40, v40
    v_exp_f32 v41, v41
    v_smfmac_f32_32x32x32_bf16 v[168:183], v[24:27], v[32:39], v158
    v_exp_f32 v42, v42
    v_exp_f32 v43, v43
    v_exp_f32 v44, v44
    v_exp_f32 v45, v45
    v_exp_f32 v46, v46
    v_exp_f32 v47, v47
    v_exp_f32 v48, v48
    v_exp_f32 v49, v49
    s_waitcnt lgkmcnt(0)
    v_smfmac_f32_32x32x32_bf16 v[168:183], v[20:23], v[40:47], v158
    v_exp_f32 v50, v50
    v_exp_f32 v51, v51
    v_exp_f32 v52, v52
    v_mfma_f32_32x32x16_bf16 v[32:47], v[16:19], v[200:203], 4.0
    v_exp_f32 v53, v53
    v_exp_f32 v54, v54
    v_exp_f32 v55, v55
    v_exp_f32 v56, v56
    v_exp_f32 v57, v57
    v_smfmac_f32_32x32x32_bf16 v[184:199], v[24:27], v[48:55], v158
    v_exp_f32 v58, v58
    v_exp_f32 v59, v59
    v_exp_f32 v60, v60
    v_exp_f32 v61, v61
    v_exp_f32 v62, v62
    v_exp_f32 v63, v63
    v_exp_f32 v32, v32
    v_exp_f32 v33, v33
    v_smfmac_f32_32x32x32_bf16 v[184:199], v[20:23], v[56:63], v158
    v_exp_f32 v34, v34
    v_exp_f32 v35, v35
    v_exp_f32 v36, v36
    v_mfma_f32_32x32x16_bf16 v[48:63], v[16:19], v[204:207], 4.0
    ds_read_b128 v[16:19], v159 offset:4096
    ds_read_b128 v[20:23], v160 offset:3584
    ds_read_b128 v[24:27], v160 offset:4096
    v_exp_f32 v37, v37
    v_exp_f32 v38, v38
    v_exp_f32 v39, v39
    v_exp_f32 v40, v40
    v_exp_f32 v41, v41
    v_smfmac_f32_32x32x32_bf16 v[168:183], v[28:31], v[32:39], v158
    v_exp_f32 v42, v42
    v_exp_f32 v43, v43
    v_exp_f32 v44, v44
    v_exp_f32 v45, v45
    v_exp_f32 v46, v46
    v_exp_f32 v47, v47
    v_exp_f32 v48, v48
    v_exp_f32 v49, v49
    s_waitcnt lgkmcnt(0)
    v_smfmac_f32_32x32x32_bf16 v[168:183], v[20:23], v[40:47], v158
    v_exp_f32 v50, v50
    v_exp_f32 v51, v51
    v_exp_f32 v52, v52
    v_mfma_f32_32x32x16_bf16 v[32:47], v[16:19], v[200:203], 4.0
    v_exp_f32 v53, v53
    v_exp_f32 v54, v54
    v_exp_f32 v55, v55
    v_exp_f32 v56, v56
    v_exp_f32 v57, v57
    v_smfmac_f32_32x32x32_bf16 v[184:199], v[28:31], v[48:55], v158
    v_exp_f32 v58, v58
    v_exp_f32 v59, v59
    v_exp_f32 v60, v60
    v_exp_f32 v61, v61
    v_exp_f32 v62, v62
    v_exp_f32 v63, v63
    v_exp_f32 v32, v32
    v_exp_f32 v33, v33
    v_smfmac_f32_32x32x32_bf16 v[184:199], v[20:23], v[56:63], v158
    v_exp_f32 v34, v34
    v_exp_f32 v35, v35
    v_exp_f32 v36, v36
    v_mfma_f32_32x32x16_bf16 v[48:63], v[16:19], v[204:207], 4.0
    ds_read_b128 v[16:19], v159 offset:5120
    ds_read_b128 v[20:23], v160 offset:4608
    ds_read_b128 v[28:31], v160 offset:5120
    v_exp_f32 v37, v37
    v_exp_f32 v38, v38
    v_exp_f32 v39, v39
    v_exp_f32 v40, v40
    v_exp_f32 v41, v41
    v_smfmac_f32_32x32x32_bf16 v[168:183], v[24:27], v[32:39], v158
    v_exp_f32 v42, v42
    v_exp_f32 v43, v43
    v_exp_f32 v44, v44
    v_exp_f32 v45, v45
    v_exp_f32 v46, v46
    v_exp_f32 v47, v47
    v_exp_f32 v48, v48
    v_exp_f32 v49, v49
    s_waitcnt lgkmcnt(0)
    v_smfmac_f32_32x32x32_bf16 v[168:183], v[20:23], v[40:47], v158
    v_exp_f32 v50, v50
    v_exp_f32 v51, v51
    v_exp_f32 v52, v52
    v_mfma_f32_32x32x16_bf16 v[32:47], v[16:19], v[200:203], 4.0
    v_exp_f32 v53, v53
    v_exp_f32 v54, v54
    v_exp_f32 v55, v55
    v_exp_f32 v56, v56
    v_exp_f32 v57, v57
    v_smfmac_f32_32x32x32_bf16 v[184:199], v[24:27], v[48:55], v158
    v_exp_f32 v58, v58
    v_exp_f32 v59, v59
    v_exp_f32 v60, v60
    v_exp_f32 v61, v61
    v_exp_f32 v62, v62
    v_exp_f32 v63, v63
    v_exp_f32 v32, v32
    v_exp_f32 v33, v33
    v_smfmac_f32_32x32x32_bf16 v[184:199], v[20:23], v[56:63], v158
    v_exp_f32 v34, v34
    v_exp_f32 v35, v35
    v_exp_f32 v36, v36
    v_mfma_f32_32x32x16_bf16 v[48:63], v[16:19], v[204:207], 4.0
    ds_read_b128 v[16:19], v159 offset:6144
    ds_read_b128 v[20:23], v160 offset:5632
    ds_read_b128 v[24:27], v160 offset:6144
    v_exp_f32 v37, v37
    v_exp_f32 v38, v38
    v_exp_f32 v39, v39
    v_exp_f32 v40, v40
    v_exp_f32 v41, v41
    v_smfmac_f32_32x32x32_bf16 v[168:183], v[28:31], v[32:39], v158
    v_exp_f32 v42, v42
    v_exp_f32 v43, v43
    v_exp_f32 v44, v44
    v_exp_f32 v45, v45
    v_exp_f32 v46, v46
    v_exp_f32 v47, v47
    v_exp_f32 v48, v48
    v_exp_f32 v49, v49
    s_waitcnt lgkmcnt(0)
    v_smfmac_f32_32x32x32_bf16 v[168:183], v[20:23], v[40:47], v158
    v_exp_f32 v50, v50
    v_exp_f32 v51, v51
    v_exp_f32 v52, v52
    v_mfma_f32_32x32x16_bf16 v[32:47], v[16:19], v[200:203], 4.0
    v_exp_f32 v53, v53
    v_exp_f32 v54, v54
    v_exp_f32 v55, v55
    v_exp_f32 v56, v56
    v_exp_f32 v57, v57
    v_smfmac_f32_32x32x32_bf16 v[184:199], v[28:31], v[48:55], v158
    v_exp_f32 v58, v58
    v_exp_f32 v59, v59
    v_exp_f32 v60, v60
    v_exp_f32 v61, v61
    v_exp_f32 v62, v62
    v_exp_f32 v63, v63
    v_exp_f32 v32, v32
    v_exp_f32 v33, v33
    v_smfmac_f32_32x32x32_bf16 v[184:199], v[20:23], v[56:63], v158
    v_exp_f32 v34, v34
    v_exp_f32 v35, v35
    v_exp_f32 v36, v36
    v_mfma_f32_32x32x16_bf16 v[48:63], v[16:19], v[204:207], 4.0
    ds_read_b128 v[16:19], v159 offset:7168
    ds_read_b128 v[20:23], v160 offset:6656
    ds_read_b128 v[28:31], v160 offset:7168
    v_exp_f32 v37, v37
    v_exp_f32 v38, v38
    v_exp_f32 v39, v39
    v_exp_f32 v40, v40
    v_exp_f32 v41, v41
    v_smfmac_f32_32x32x32_bf16 v[168:183], v[24:27], v[32:39], v158
    v_exp_f32 v42, v42
    v_exp_f32 v43, v43
    v_exp_f32 v44, v44
    v_exp_f32 v45, v45
    v_exp_f32 v46, v46
    v_exp_f32 v47, v47
    v_exp_f32 v48, v48
    v_exp_f32 v49, v49
    s_waitcnt lgkmcnt(0)
    v_smfmac_f32_32x32x32_bf16 v[168:183], v[20:23], v[40:47], v158
    v_exp_f32 v50, v50
    v_exp_f32 v51, v51
    v_exp_f32 v52, v52
    v_mfma_f32_32x32x16_bf16 v[32:47], v[16:19], v[200:203], 4.0
    v_exp_f32 v53, v53
    v_exp_f32 v54, v54
    v_exp_f32 v55, v55
    v_exp_f32 v56, v56
    v_exp_f32 v57, v57
    v_smfmac_f32_32x32x32_bf16 v[184:199], v[24:27], v[48:55], v158
    v_exp_f32 v58, v58
    v_exp_f32 v59, v59
    v_exp_f32 v60, v60
    v_exp_f32 v61, v61
    v_exp_f32 v62, v62
    v_exp_f32 v63, v63
    v_exp_f32 v32, v32
    v_exp_f32 v33, v33
    v_smfmac_f32_32x32x32_bf16 v[184:199], v[20:23], v[56:63], v158
    v_exp_f32 v34, v34
    v_exp_f32 v35, v35
    v_exp_f32 v36, v36
    v_mfma_f32_32x32x16_bf16 v[48:63], v[16:19], v[204:207], 4.0
    ds_read_b128 v[20:23], v160 offset:7680
    v_add_u32 v159, s7, v155
    v_mad_u32_u24 v160, v157, s7, v156
    s_add_u32 s7, s7, 32768
    s_and_b32 s7, s7, 0x1ffff
    ds_read_b128 v[16:19], v159 offset:0
    ds_read_b128 v[24:27], v160 offset:0
    v_exp_f32 v37, v37
    v_exp_f32 v38, v38
    v_exp_f32 v39, v39
    v_exp_f32 v40, v40
    v_exp_f32 v41, v41
    v_smfmac_f32_32x32x32_bf16 v[168:183], v[28:31], v[32:39], v158
    v_exp_f32 v42, v42
    v_exp_f32 v43, v43
    v_exp_f32 v44, v44
    v_exp_f32 v45, v45
    v_exp_f32 v46, v46
    v_exp_f32 v47, v47
    v_exp_f32 v48, v48
    v_exp_f32 v49, v49
    s_waitcnt lgkmcnt(0)
    v_smfmac_f32_32x32x32_bf16 v[168:183], v[20:23], v[40:47], v158
    v_exp_f32 v50, v50
    v_exp_f32 v51, v51
    v_exp_f32 v52, v52
    v_mfma_f32_32x32x16_bf16 v[32:47], v[16:19], v[200:203], 4.0
    v_exp_f32 v53, v53
    v_exp_f32 v54, v54
    v_exp_f32 v55, v55
    v_exp_f32 v56, v56
    v_exp_f32 v57, v57
    v_smfmac_f32_32x32x32_bf16 v[184:199], v[28:31], v[48:55], v158
    v_exp_f32 v58, v58
    v_exp_f32 v59, v59
    v_exp_f32 v60, v60
    v_exp_f32 v61, v61
    v_exp_f32 v62, v62
    v_exp_f32 v63, v63
    v_exp_f32 v32, v32
    v_exp_f32 v33, v33
    v_smfmac_f32_32x32x32_bf16 v[184:199], v[20:23], v[56:63], v158
    s_sub_u32 s8, s8, 1

    s_cmp_lg_u32 s8, 0
    s_cbranch_scc1 gated_mix__softmax_full_mha__softmax_full_mha__prompt_kernel_free

    s_mov_b32 s60, 0x21800000
    s_mov_b32 s61, 0x5d800000
    s_mov_b32 s62, 0x7e800000
    v_pk_add_f32 v[16:17], v[168:169], v[170:171]
    v_pk_add_f32 v[18:19], v[172:173], v[174:175]
    v_cmp_le_f32 vcc, s60, v176
    v_cmp_ge_f32 s[96:97], s61, v176
    v_pk_add_f32 v[16:17], v[16:17], v[18:19]
    s_and_b64 s[96:97], s[96:97], vcc
    s_nop 3
    v_pk_add_f32 v[18:19], v[184:185], v[186:187]
    v_pk_add_f32 v[20:21], v[188:189], v[190:191]
    v_cmp_le_f32 vcc, s60, v192
    v_pk_add_f32 v[16:17], v[16:17], v[18:19]
    s_and_b64 s[96:97], s[96:97], vcc
    v_cmp_ge_f32 vcc, s61, v192
    v_pk_add_f32 v[16:17], v[16:17], v[20:21]
    s_and_b64 s[96:97], s[96:97], vcc
    v_add_f32 v16, v16, v17
    v_cmp_ge_f32 vcc, s62, |v16|
    s_and_b64 s[96:97], s[96:97], vcc
    s_cmp_eq_u64 s[96:97], exec
    s_cbranch_scc0 gated_mix__softmax_full_mha__softmax_full_mha__prompt_kernel_safe

gated_mix__softmax_full_mha__softmax_full_mha__prompt_kernel_fin:
    v_rcp_f32 v2, v176
    v_rcp_f32 v4, v192
    s_waitcnt vmcnt(32)
    v_mul_f32 v2, v2, v162
    v_mul_f32 v4, v4, v163

    v_pk_mul_f32 v[168:169], v[168:169], v[2:3] op_sel_hi:[1,0]
    v_pk_mul_f32 v[170:171], v[170:171], v[2:3] op_sel_hi:[1,0]
    v_pk_mul_f32 v[172:173], v[172:173], v[2:3] op_sel_hi:[1,0]
    v_pk_mul_f32 v[174:175], v[174:175], v[2:3] op_sel_hi:[1,0]
    v_cvt_pk_bf16_f32 v200, v168, v169
    v_cvt_pk_bf16_f32 v201, v170, v171
    v_cvt_pk_bf16_f32 v202, v172, v173
    v_cvt_pk_bf16_f32 v203, v174, v175
    v_min_u32 v203, -2, v203
    buffer_store_dwordx4 v[200:203], v1, s[32:35], s10 offen sc1
    v_pk_mul_f32 v[184:185], v[184:185], v[4:5] op_sel_hi:[1,0]
    v_pk_mul_f32 v[186:187], v[186:187], v[4:5] op_sel_hi:[1,0]
    v_pk_mul_f32 v[188:189], v[188:189], v[4:5] op_sel_hi:[1,0]
    v_pk_mul_f32 v[190:191], v[190:191], v[4:5] op_sel_hi:[1,0]
    v_cvt_pk_bf16_f32 v204, v184, v185
    v_cvt_pk_bf16_f32 v205, v186, v187
    v_cvt_pk_bf16_f32 v206, v188, v189
    v_cvt_pk_bf16_f32 v207, v190, v191
    v_min_u32 v207, -2, v207
    buffer_store_dwordx4 v[204:207], v1, s[32:35], s11 offen sc1
    s_bfe_u32 s60, s3, 0x10001
    s_lshl_b32 s60, s60, 8
    v_xor_b32 v153, s60, v1

    s_and_b32 s60, s3, 3
    s_lshl_b32 s61, s60, 13
    v_add_u32 v152, s61, v1
    s_mov_b32 s19, 31
    s_cmp_lt_u32 s3, 4
    s_cbranch_scc1 gated_mix__softmax_full_mha__softmax_full_mha__prompt_kernel_even

    s_barrier
    s_mov_b32 s19, 15

    buffer_load_dwordx4 v[16:19], v153, s[32:35], s98 offen offset:0 sc1
    buffer_load_dwordx4 v[20:23], v153, s[32:35], s98 offen offset:1024 sc1
    buffer_load_dwordx4 v[24:27], v153, s[32:35], s98 offen offset:2048 sc1
    buffer_load_dwordx4 v[28:31], v153, s[32:35], s98 offen offset:3072 sc1
    s_barrier
    buffer_load_dwordx4 v[32:35], v153, s[32:35], s99 offen offset:0 sc1
    buffer_load_dwordx4 v[36:39], v153, s[32:35], s99 offen offset:1024 sc1
    buffer_load_dwordx4 v[40:43], v153, s[32:35], s99 offen offset:2048 sc1
    buffer_load_dwordx4 v[44:47], v153, s[32:35], s99 offen offset:3072 sc1
    ds_read_b128 v[168:171], v152 offset:0
    ds_read_b128 v[172:175], v152 offset:1024
    ds_read_b128 v[176:179], v152 offset:2048
    ds_read_b128 v[180:183], v152 offset:3072
    ds_read_b128 v[184:187], v152 offset:4096
    ds_read_b128 v[188:191], v152 offset:5120
    ds_read_b128 v[192:195], v152 offset:6144
    ds_read_b128 v[196:199], v152 offset:7168
    s_lshl_b32 s61, s60, 12
    s_add_u32 s61, s61, 32768
    v_add_u32 v152, s61, v1
    s_xor_b32 s61, s61, 8192
    v_add_u32 v155, s61, v1
    v_lshrrev_b32 v2, 5, v0
    v_and_b32 v3, 31, v0
    v_lshlrev_b32 v3, 2, v3
    v_lshl_add_u32 v154, v2, 12, v3
    s_add_u32 s10, s22, 8192
    s_waitcnt lgkmcnt(0)

    s_waitcnt vmcnt(4)
    v_max3_u32 v2, v19, v23, v27
    v_max_u32 v2, v2, v31
    v_cmp_eq_u32 vcc, -1, v2
    s_cbranch_vccnz gated_mix__softmax_full_mha__softmax_full_mha__prompt_kernel_fskip0
    s_bitset0_b32 s19, 0

    v_mfma_f32_32x32x16_bf16 v[168:183], v[16:19], v[64:67], v[168:183]
    buffer_load_dwordx4 v[48:51], v153, s[32:35], s100 offen offset:0 sc1
    v_mfma_f32_32x32x16_bf16 v[184:199], v[16:19], v[68:71], v[184:199]
    v_mfma_f32_32x32x16_bf16 v[168:183], v[20:23], v[72:75], v[168:183]
    buffer_load_dwordx4 v[52:55], v153, s[32:35], s100 offen offset:1024 sc1
    v_mfma_f32_32x32x16_bf16 v[184:199], v[20:23], v[76:79], v[184:199]
    v_mfma_f32_32x32x16_bf16 v[168:183], v[24:27], v[80:83], v[168:183]
    buffer_load_dwordx4 v[56:59], v153, s[32:35], s100 offen offset:2048 sc1
    v_mfma_f32_32x32x16_bf16 v[184:199], v[24:27], v[84:87], v[184:199]
    v_mfma_f32_32x32x16_bf16 v[168:183], v[28:31], v[88:91], v[168:183]
    buffer_load_dwordx4 v[60:63], v153, s[32:35], s100 offen offset:3072 sc1
    v_mfma_f32_32x32x16_bf16 v[184:199], v[28:31], v[92:95], v[184:199]
gated_mix__softmax_full_mha__softmax_full_mha__prompt_kernel_fnext0:
    s_waitcnt vmcnt(4)
    v_max3_u32 v2, v35, v39, v43
    v_max_u32 v2, v2, v47
    v_cmp_eq_u32 vcc, -1, v2
    s_cbranch_vccnz gated_mix__softmax_full_mha__softmax_full_mha__prompt_kernel_fskip1
    s_bitset0_b32 s19, 1

    v_mfma_f32_32x32x16_bf16 v[168:183], v[32:35], v[96:99], v[168:183]
    buffer_load_dwordx4 v[248:251], v153, s[32:35], s101 offen offset:0 sc1
    v_mfma_f32_32x32x16_bf16 v[184:199], v[32:35], v[100:103], v[184:199]
    v_mfma_f32_32x32x16_bf16 v[168:183], v[36:39], v[104:107], v[168:183]
    buffer_load_dwordx4 v[252:255], v153, s[32:35], s101 offen offset:1024 sc1
    v_mfma_f32_32x32x16_bf16 v[184:199], v[36:39], v[108:111], v[184:199]
    v_mfma_f32_32x32x16_bf16 v[168:183], v[40:43], v[112:115], v[168:183]
    buffer_load_dwordx4 v[8:11], v153, s[32:35], s101 offen offset:2048 sc1
    v_mfma_f32_32x32x16_bf16 v[184:199], v[40:43], v[116:119], v[184:199]
    v_mfma_f32_32x32x16_bf16 v[168:183], v[44:47], v[120:123], v[168:183]
    buffer_load_dwordx4 v[12:15], v153, s[32:35], s101 offen offset:3072 sc1
    v_mfma_f32_32x32x16_bf16 v[184:199], v[44:47], v[124:127], v[184:199]
gated_mix__softmax_full_mha__softmax_full_mha__prompt_kernel_fnext1:
    s_waitcnt vmcnt(4)
    v_max3_u32 v2, v51, v55, v59
    v_max_u32 v2, v2, v63
    v_cmp_eq_u32 vcc, -1, v2
    s_cbranch_vccnz gated_mix__softmax_full_mha__softmax_full_mha__prompt_kernel_fskip2
    s_bitset0_b32 s19, 2

    v_mfma_f32_32x32x16_bf16 v[168:183], v[48:51], v[128:131], v[168:183]
    v_mfma_f32_32x32x16_bf16 v[184:199], v[48:51], v[132:135], v[184:199]
    v_mfma_f32_32x32x16_bf16 v[168:183], v[52:55], v[136:139], v[168:183]
    v_mfma_f32_32x32x16_bf16 v[184:199], v[52:55], v[140:143], v[184:199]
    v_mfma_f32_32x32x16_bf16 v[168:183], v[56:59], v[144:147], v[168:183]
    v_mfma_f32_32x32x16_bf16 v[184:199], v[56:59], v[148:151], v[184:199]
    v_mfma_f32_32x32x16_bf16 v[168:183], v[60:63], v[208:211], v[168:183]
    v_mfma_f32_32x32x16_bf16 v[184:199], v[60:63], v[212:215], v[184:199]
gated_mix__softmax_full_mha__softmax_full_mha__prompt_kernel_fnext2:
    s_waitcnt vmcnt(0)
    v_max3_u32 v2, v251, v255, v11
    v_max_u32 v2, v2, v15
    v_cmp_eq_u32 vcc, -1, v2
    s_cbranch_vccnz gated_mix__softmax_full_mha__softmax_full_mha__prompt_kernel_fskip3
    s_bitset0_b32 s19, 3

    v_mfma_f32_32x32x16_bf16 v[168:183], v[248:251], v[216:219], v[168:183]
    v_mfma_f32_32x32x16_bf16 v[184:199], v[248:251], v[220:223], v[184:199]
    v_mfma_f32_32x32x16_bf16 v[168:183], v[252:255], v[224:227], v[168:183]
    v_mfma_f32_32x32x16_bf16 v[184:199], v[252:255], v[228:231], v[184:199]
    v_mfma_f32_32x32x16_bf16 v[168:183], v[8:11], v[232:235], v[168:183]
    v_mfma_f32_32x32x16_bf16 v[184:199], v[8:11], v[236:239], v[184:199]
    v_mfma_f32_32x32x16_bf16 v[168:183], v[12:15], v[240:243], v[168:183]
    v_mfma_f32_32x32x16_bf16 v[184:199], v[12:15], v[244:247], v[184:199]
gated_mix__softmax_full_mha__softmax_full_mha__prompt_kernel_fnext3:
    s_branch gated_mix__softmax_full_mha__softmax_full_mha__prompt_kernel_odone
gated_mix__softmax_full_mha__softmax_full_mha__prompt_kernel_fskip0:
    buffer_load_dwordx4 v[48:51], v153, s[32:35], s100 offen offset:0 sc1
    buffer_load_dwordx4 v[52:55], v153, s[32:35], s100 offen offset:1024 sc1
    buffer_load_dwordx4 v[56:59], v153, s[32:35], s100 offen offset:2048 sc1
    buffer_load_dwordx4 v[60:63], v153, s[32:35], s100 offen offset:3072 sc1
    buffer_load_dwordx4 v[248:251], v153, s[32:35], s101 offen offset:0 sc1
    buffer_load_dwordx4 v[252:255], v153, s[32:35], s101 offen offset:1024 sc1
    buffer_load_dwordx4 v[8:11], v153, s[32:35], s101 offen offset:2048 sc1
    buffer_load_dwordx4 v[12:15], v153, s[32:35], s101 offen offset:3072 sc1
    buffer_load_dwordx4 v[16:19], v153, s[32:35], s98 offen offset:0 sc1
    buffer_load_dwordx4 v[20:23], v153, s[32:35], s98 offen offset:1024 sc1
    buffer_load_dwordx4 v[24:27], v153, s[32:35], s98 offen offset:2048 sc1
    buffer_load_dwordx4 v[28:31], v153, s[32:35], s98 offen offset:3072 sc1
    s_mov_b32 s20, 4
    s_branch gated_mix__softmax_full_mha__softmax_full_mha__prompt_kernel_oskip0
gated_mix__softmax_full_mha__softmax_full_mha__prompt_kernel_fskip1:
    buffer_load_dwordx4 v[248:251], v153, s[32:35], s101 offen offset:0 sc1
    buffer_load_dwordx4 v[252:255], v153, s[32:35], s101 offen offset:1024 sc1
    buffer_load_dwordx4 v[8:11], v153, s[32:35], s101 offen offset:2048 sc1
    buffer_load_dwordx4 v[12:15], v153, s[32:35], s101 offen offset:3072 sc1
    buffer_load_dwordx4 v[32:35], v153, s[32:35], s99 offen offset:0 sc1
    buffer_load_dwordx4 v[36:39], v153, s[32:35], s99 offen offset:1024 sc1
    buffer_load_dwordx4 v[40:43], v153, s[32:35], s99 offen offset:2048 sc1
    buffer_load_dwordx4 v[44:47], v153, s[32:35], s99 offen offset:3072 sc1
    s_mov_b32 s20, 3
    s_branch gated_mix__softmax_full_mha__softmax_full_mha__prompt_kernel_oskip1
gated_mix__softmax_full_mha__softmax_full_mha__prompt_kernel_fskip2:
    buffer_load_dwordx4 v[48:51], v153, s[32:35], s100 offen offset:0 sc1
    buffer_load_dwordx4 v[52:55], v153, s[32:35], s100 offen offset:1024 sc1
    buffer_load_dwordx4 v[56:59], v153, s[32:35], s100 offen offset:2048 sc1
    buffer_load_dwordx4 v[60:63], v153, s[32:35], s100 offen offset:3072 sc1
    s_mov_b32 s20, 2
    s_branch gated_mix__softmax_full_mha__softmax_full_mha__prompt_kernel_oskip2
gated_mix__softmax_full_mha__softmax_full_mha__prompt_kernel_fskip3:
    buffer_load_dwordx4 v[248:251], v153, s[32:35], s101 offen offset:0 sc1
    buffer_load_dwordx4 v[252:255], v153, s[32:35], s101 offen offset:1024 sc1
    buffer_load_dwordx4 v[8:11], v153, s[32:35], s101 offen offset:2048 sc1
    buffer_load_dwordx4 v[12:15], v153, s[32:35], s101 offen offset:3072 sc1
    s_mov_b32 s20, 1
    s_branch gated_mix__softmax_full_mha__softmax_full_mha__prompt_kernel_ochk
gated_mix__softmax_full_mha__softmax_full_mha__prompt_kernel_even:
    buffer_load_dwordx4 v[16:19], v153, s[32:35], s98 offen offset:0 sc1
    buffer_load_dwordx4 v[20:23], v153, s[32:35], s98 offen offset:1024 sc1
    buffer_load_dwordx4 v[24:27], v153, s[32:35], s98 offen offset:2048 sc1
    buffer_load_dwordx4 v[28:31], v153, s[32:35], s98 offen offset:3072 sc1
    buffer_load_dwordx4 v[32:35], v153, s[32:35], s99 offen offset:0 sc1
    buffer_load_dwordx4 v[36:39], v153, s[32:35], s99 offen offset:1024 sc1
    buffer_load_dwordx4 v[40:43], v153, s[32:35], s99 offen offset:2048 sc1
    buffer_load_dwordx4 v[44:47], v153, s[32:35], s99 offen offset:3072 sc1
    buffer_load_dwordx4 v[48:51], v153, s[32:35], s100 offen offset:0 sc1
    buffer_load_dwordx4 v[52:55], v153, s[32:35], s100 offen offset:1024 sc1
    buffer_load_dwordx4 v[56:59], v153, s[32:35], s100 offen offset:2048 sc1
    buffer_load_dwordx4 v[60:63], v153, s[32:35], s100 offen offset:3072 sc1
    buffer_load_dwordx4 v[248:251], v153, s[32:35], s101 offen offset:0 sc1
    buffer_load_dwordx4 v[252:255], v153, s[32:35], s101 offen offset:1024 sc1
    buffer_load_dwordx4 v[8:11], v153, s[32:35], s101 offen offset:2048 sc1
    buffer_load_dwordx4 v[12:15], v153, s[32:35], s101 offen offset:3072 sc1
    s_setprio 0
    s_mov_b32 s20, 4
gated_mix__softmax_full_mha__softmax_full_mha__prompt_kernel_ochk:
    s_bitcmp1_b32 s19, 0
    s_cbranch_scc0 gated_mix__softmax_full_mha__softmax_full_mha__prompt_kernel_oskip0

    s_waitcnt vmcnt(12)
    s_cmp_eq_u32 s20, 4
    s_cbranch_scc1 gated_mix__softmax_full_mha__softmax_full_mha__prompt_kernel_ogo0

    s_waitcnt vmcnt(8)
    s_cmp_eq_u32 s20, 3
    s_cbranch_scc1 gated_mix__softmax_full_mha__softmax_full_mha__prompt_kernel_ogo0

    s_waitcnt vmcnt(4)
    s_cmp_eq_u32 s20, 2
    s_cbranch_scc1 gated_mix__softmax_full_mha__softmax_full_mha__prompt_kernel_ogo0

    s_waitcnt vmcnt(0)
gated_mix__softmax_full_mha__softmax_full_mha__prompt_kernel_ogo0:
    v_max3_u32 v2, v19, v23, v27
    v_max_u32 v2, v2, v31
    v_cmp_eq_u32 vcc, -1, v2
    s_cbranch_vccnz gated_mix__softmax_full_mha__softmax_full_mha__prompt_kernel_oagain0
    s_bitset0_b32 s19, 0

    s_sub_u32 s20, s20, 1
    s_bitcmp1_b32 s19, 4
    s_cbranch_scc1 gated_mix__softmax_full_mha__softmax_full_mha__prompt_kernel_ofirst0

    v_mfma_f32_32x32x16_bf16 v[168:183], v[16:19], v[64:67], v[168:183]
    v_mfma_f32_32x32x16_bf16 v[184:199], v[16:19], v[68:71], v[184:199]
gated_mix__softmax_full_mha__softmax_full_mha__prompt_kernel_orest0:
    v_mfma_f32_32x32x16_bf16 v[168:183], v[20:23], v[72:75], v[168:183]
    v_mfma_f32_32x32x16_bf16 v[184:199], v[20:23], v[76:79], v[184:199]
    v_mfma_f32_32x32x16_bf16 v[168:183], v[24:27], v[80:83], v[168:183]
    v_mfma_f32_32x32x16_bf16 v[184:199], v[24:27], v[84:87], v[184:199]
    v_mfma_f32_32x32x16_bf16 v[168:183], v[28:31], v[88:91], v[168:183]
    v_mfma_f32_32x32x16_bf16 v[184:199], v[28:31], v[92:95], v[184:199]
gated_mix__softmax_full_mha__softmax_full_mha__prompt_kernel_oskip0:
    s_bitcmp1_b32 s19, 1
    s_cbranch_scc0 gated_mix__softmax_full_mha__softmax_full_mha__prompt_kernel_oskip1

    s_waitcnt vmcnt(12)
    s_cmp_eq_u32 s20, 4
    s_cbranch_scc1 gated_mix__softmax_full_mha__softmax_full_mha__prompt_kernel_ogo1

    s_waitcnt vmcnt(8)
    s_cmp_eq_u32 s20, 3
    s_cbranch_scc1 gated_mix__softmax_full_mha__softmax_full_mha__prompt_kernel_ogo1

    s_waitcnt vmcnt(4)
    s_cmp_eq_u32 s20, 2
    s_cbranch_scc1 gated_mix__softmax_full_mha__softmax_full_mha__prompt_kernel_ogo1

    s_waitcnt vmcnt(0)
gated_mix__softmax_full_mha__softmax_full_mha__prompt_kernel_ogo1:
    v_max3_u32 v2, v35, v39, v43
    v_max_u32 v2, v2, v47
    v_cmp_eq_u32 vcc, -1, v2
    s_cbranch_vccnz gated_mix__softmax_full_mha__softmax_full_mha__prompt_kernel_oagain1
    s_bitset0_b32 s19, 1

    s_sub_u32 s20, s20, 1
    s_bitcmp1_b32 s19, 4
    s_cbranch_scc1 gated_mix__softmax_full_mha__softmax_full_mha__prompt_kernel_ofirst1

    v_mfma_f32_32x32x16_bf16 v[168:183], v[32:35], v[96:99], v[168:183]
    v_mfma_f32_32x32x16_bf16 v[184:199], v[32:35], v[100:103], v[184:199]
gated_mix__softmax_full_mha__softmax_full_mha__prompt_kernel_orest1:
    v_mfma_f32_32x32x16_bf16 v[168:183], v[36:39], v[104:107], v[168:183]
    v_mfma_f32_32x32x16_bf16 v[184:199], v[36:39], v[108:111], v[184:199]
    v_mfma_f32_32x32x16_bf16 v[168:183], v[40:43], v[112:115], v[168:183]
    v_mfma_f32_32x32x16_bf16 v[184:199], v[40:43], v[116:119], v[184:199]
    v_mfma_f32_32x32x16_bf16 v[168:183], v[44:47], v[120:123], v[168:183]
    v_mfma_f32_32x32x16_bf16 v[184:199], v[44:47], v[124:127], v[184:199]
gated_mix__softmax_full_mha__softmax_full_mha__prompt_kernel_oskip1:
    s_bitcmp1_b32 s19, 2
    s_cbranch_scc0 gated_mix__softmax_full_mha__softmax_full_mha__prompt_kernel_oskip2

    s_waitcnt vmcnt(12)
    s_cmp_eq_u32 s20, 4
    s_cbranch_scc1 gated_mix__softmax_full_mha__softmax_full_mha__prompt_kernel_ogo2

    s_waitcnt vmcnt(8)
    s_cmp_eq_u32 s20, 3
    s_cbranch_scc1 gated_mix__softmax_full_mha__softmax_full_mha__prompt_kernel_ogo2

    s_waitcnt vmcnt(4)
    s_cmp_eq_u32 s20, 2
    s_cbranch_scc1 gated_mix__softmax_full_mha__softmax_full_mha__prompt_kernel_ogo2

    s_waitcnt vmcnt(0)
gated_mix__softmax_full_mha__softmax_full_mha__prompt_kernel_ogo2:
    v_max3_u32 v2, v51, v55, v59
    v_max_u32 v2, v2, v63
    v_cmp_eq_u32 vcc, -1, v2
    s_cbranch_vccnz gated_mix__softmax_full_mha__softmax_full_mha__prompt_kernel_oagain2
    s_bitset0_b32 s19, 2

    s_sub_u32 s20, s20, 1
    s_bitcmp1_b32 s19, 4
    s_cbranch_scc1 gated_mix__softmax_full_mha__softmax_full_mha__prompt_kernel_ofirst2

    v_mfma_f32_32x32x16_bf16 v[168:183], v[48:51], v[128:131], v[168:183]
    v_mfma_f32_32x32x16_bf16 v[184:199], v[48:51], v[132:135], v[184:199]
gated_mix__softmax_full_mha__softmax_full_mha__prompt_kernel_orest2:
    v_mfma_f32_32x32x16_bf16 v[168:183], v[52:55], v[136:139], v[168:183]
    v_mfma_f32_32x32x16_bf16 v[184:199], v[52:55], v[140:143], v[184:199]
    v_mfma_f32_32x32x16_bf16 v[168:183], v[56:59], v[144:147], v[168:183]
    v_mfma_f32_32x32x16_bf16 v[184:199], v[56:59], v[148:151], v[184:199]
    v_mfma_f32_32x32x16_bf16 v[168:183], v[60:63], v[208:211], v[168:183]
    v_mfma_f32_32x32x16_bf16 v[184:199], v[60:63], v[212:215], v[184:199]
gated_mix__softmax_full_mha__softmax_full_mha__prompt_kernel_oskip2:
    s_bitcmp1_b32 s19, 3
    s_cbranch_scc0 gated_mix__softmax_full_mha__softmax_full_mha__prompt_kernel_oskip3

    s_waitcnt vmcnt(12)
    s_cmp_eq_u32 s20, 4
    s_cbranch_scc1 gated_mix__softmax_full_mha__softmax_full_mha__prompt_kernel_ogo3

    s_waitcnt vmcnt(8)
    s_cmp_eq_u32 s20, 3
    s_cbranch_scc1 gated_mix__softmax_full_mha__softmax_full_mha__prompt_kernel_ogo3

    s_waitcnt vmcnt(4)
    s_cmp_eq_u32 s20, 2
    s_cbranch_scc1 gated_mix__softmax_full_mha__softmax_full_mha__prompt_kernel_ogo3

    s_waitcnt vmcnt(0)
gated_mix__softmax_full_mha__softmax_full_mha__prompt_kernel_ogo3:
    v_max3_u32 v2, v251, v255, v11
    v_max_u32 v2, v2, v15
    v_cmp_eq_u32 vcc, -1, v2
    s_cbranch_vccnz gated_mix__softmax_full_mha__softmax_full_mha__prompt_kernel_oagain3
    s_bitset0_b32 s19, 3

    s_sub_u32 s20, s20, 1
    s_bitcmp1_b32 s19, 4
    s_cbranch_scc1 gated_mix__softmax_full_mha__softmax_full_mha__prompt_kernel_ofirst3

    v_mfma_f32_32x32x16_bf16 v[168:183], v[248:251], v[216:219], v[168:183]
    v_mfma_f32_32x32x16_bf16 v[184:199], v[248:251], v[220:223], v[184:199]
gated_mix__softmax_full_mha__softmax_full_mha__prompt_kernel_orest3:
    v_mfma_f32_32x32x16_bf16 v[168:183], v[252:255], v[224:227], v[168:183]
    v_mfma_f32_32x32x16_bf16 v[184:199], v[252:255], v[228:231], v[184:199]
    v_mfma_f32_32x32x16_bf16 v[168:183], v[8:11], v[232:235], v[168:183]
    v_mfma_f32_32x32x16_bf16 v[184:199], v[8:11], v[236:239], v[184:199]
    v_mfma_f32_32x32x16_bf16 v[168:183], v[12:15], v[240:243], v[168:183]
    v_mfma_f32_32x32x16_bf16 v[184:199], v[12:15], v[244:247], v[184:199]
gated_mix__softmax_full_mha__softmax_full_mha__prompt_kernel_oskip3:
gated_mix__softmax_full_mha__softmax_full_mha__prompt_kernel_orty:
    s_cmp_eq_u32 s19, 0
    s_cbranch_scc1 gated_mix__softmax_full_mha__softmax_full_mha__prompt_kernel_odone
    s_add_u32 s18, s18, 1
    s_cmp_ge_u32 s18, 262144
    s_cbranch_scc1 gated_mix__softmax_full_mha__softmax_full_mha__prompt_kernel_odone

    s_branch gated_mix__softmax_full_mha__softmax_full_mha__prompt_kernel_ochk
gated_mix__softmax_full_mha__softmax_full_mha__prompt_kernel_oagain0:
    buffer_load_dwordx4 v[16:19], v153, s[32:35], s98 offen offset:0 sc1
    buffer_load_dwordx4 v[20:23], v153, s[32:35], s98 offen offset:1024 sc1
    buffer_load_dwordx4 v[24:27], v153, s[32:35], s98 offen offset:2048 sc1
    buffer_load_dwordx4 v[28:31], v153, s[32:35], s98 offen offset:3072 sc1
    s_branch gated_mix__softmax_full_mha__softmax_full_mha__prompt_kernel_oskip0
gated_mix__softmax_full_mha__softmax_full_mha__prompt_kernel_oagain1:
    buffer_load_dwordx4 v[32:35], v153, s[32:35], s99 offen offset:0 sc1
    buffer_load_dwordx4 v[36:39], v153, s[32:35], s99 offen offset:1024 sc1
    buffer_load_dwordx4 v[40:43], v153, s[32:35], s99 offen offset:2048 sc1
    buffer_load_dwordx4 v[44:47], v153, s[32:35], s99 offen offset:3072 sc1
    s_branch gated_mix__softmax_full_mha__softmax_full_mha__prompt_kernel_oskip1
gated_mix__softmax_full_mha__softmax_full_mha__prompt_kernel_oagain2:
    buffer_load_dwordx4 v[48:51], v153, s[32:35], s100 offen offset:0 sc1
    buffer_load_dwordx4 v[52:55], v153, s[32:35], s100 offen offset:1024 sc1
    buffer_load_dwordx4 v[56:59], v153, s[32:35], s100 offen offset:2048 sc1
    buffer_load_dwordx4 v[60:63], v153, s[32:35], s100 offen offset:3072 sc1
    s_branch gated_mix__softmax_full_mha__softmax_full_mha__prompt_kernel_oskip2
gated_mix__softmax_full_mha__softmax_full_mha__prompt_kernel_oagain3:
    buffer_load_dwordx4 v[248:251], v153, s[32:35], s101 offen offset:0 sc1
    buffer_load_dwordx4 v[252:255], v153, s[32:35], s101 offen offset:1024 sc1
    buffer_load_dwordx4 v[8:11], v153, s[32:35], s101 offen offset:2048 sc1
    buffer_load_dwordx4 v[12:15], v153, s[32:35], s101 offen offset:3072 sc1
    s_branch gated_mix__softmax_full_mha__softmax_full_mha__prompt_kernel_oskip3
gated_mix__softmax_full_mha__softmax_full_mha__prompt_kernel_ofirst0:
    v_mfma_f32_32x32x16_bf16 v[168:183], v[16:19], v[64:67], 0
    v_mfma_f32_32x32x16_bf16 v[184:199], v[16:19], v[68:71], 0
    s_bitset0_b32 s19, 4
    s_branch gated_mix__softmax_full_mha__softmax_full_mha__prompt_kernel_orest0
gated_mix__softmax_full_mha__softmax_full_mha__prompt_kernel_ofirst1:
    v_mfma_f32_32x32x16_bf16 v[168:183], v[32:35], v[96:99], 0
    v_mfma_f32_32x32x16_bf16 v[184:199], v[32:35], v[100:103], 0
    s_bitset0_b32 s19, 4
    s_branch gated_mix__softmax_full_mha__softmax_full_mha__prompt_kernel_orest1
gated_mix__softmax_full_mha__softmax_full_mha__prompt_kernel_ofirst2:
    v_mfma_f32_32x32x16_bf16 v[168:183], v[48:51], v[128:131], 0
    v_mfma_f32_32x32x16_bf16 v[184:199], v[48:51], v[132:135], 0
    s_bitset0_b32 s19, 4
    s_branch gated_mix__softmax_full_mha__softmax_full_mha__prompt_kernel_orest2
gated_mix__softmax_full_mha__softmax_full_mha__prompt_kernel_ofirst3:
    v_mfma_f32_32x32x16_bf16 v[168:183], v[248:251], v[216:219], 0
    v_mfma_f32_32x32x16_bf16 v[184:199], v[248:251], v[220:223], 0
    s_bitset0_b32 s19, 4
    s_branch gated_mix__softmax_full_mha__softmax_full_mha__prompt_kernel_orest3
gated_mix__softmax_full_mha__softmax_full_mha__prompt_kernel_odone:
    s_cmp_ge_u32 s3, 4
    s_cbranch_scc1 gated_mix__softmax_full_mha__softmax_full_mha__prompt_kernel_odd
    s_nop 10

    ds_write_b128 v152, v[168:171] offset:0
    ds_write_b128 v152, v[172:175] offset:1024
    ds_write_b128 v152, v[176:179] offset:2048
    ds_write_b128 v152, v[180:183] offset:3072
    ds_write_b128 v152, v[184:187] offset:4096
    ds_write_b128 v152, v[188:191] offset:5120
    ds_write_b128 v152, v[192:195] offset:6144
    ds_write_b128 v152, v[196:199] offset:7168
    s_waitcnt lgkmcnt(0)
    s_barrier
    s_barrier
    s_barrier
    s_branch gated_mix__softmax_full_mha__softmax_full_mha__prompt_kernel_last
gated_mix__softmax_full_mha__softmax_full_mha__prompt_kernel_odd:
    s_nop 9
    ds_write_b128 v152, v[176:179] offset:0
    ds_write_b128 v152, v[180:183] offset:1024
    ds_write_b128 v152, v[192:195] offset:2048
    ds_write_b128 v152, v[196:199] offset:3072
    s_waitcnt lgkmcnt(0)
    s_barrier
    ds_read_b128 v[16:19], v155 offset:0
    ds_read_b128 v[24:27], v155 offset:2048
    ds_read_b128 v[20:23], v155 offset:1024
    ds_read_b128 v[28:31], v155 offset:3072
    s_waitcnt lgkmcnt(2)
    v_pk_add_f32 v[168:169], v[168:169], v[16:17]
    v_pk_add_f32 v[170:171], v[170:171], v[18:19]
    v_pk_add_f32 v[184:185], v[184:185], v[24:25]
    v_pk_add_f32 v[186:187], v[186:187], v[26:27]
    v_cvt_pk_bf16_f32 v48, v168, v184
    v_cvt_pk_bf16_f32 v49, v169, v185
    v_cvt_pk_bf16_f32 v50, v170, v186
    v_cvt_pk_bf16_f32 v51, v171, v187
    buffer_store_dword v48, v154, s[40:43], s22 offen offset:0 sc1
    buffer_store_dword v49, v154, s[40:43], s22 offen offset:1024 sc1
    buffer_store_dword v50, v154, s[40:43], s22 offen offset:2048 sc1
    buffer_store_dword v51, v154, s[40:43], s22 offen offset:3072 sc1
    s_waitcnt lgkmcnt(0)
    v_pk_add_f32 v[172:173], v[172:173], v[20:21]
    v_pk_add_f32 v[174:175], v[174:175], v[22:23]
    v_pk_add_f32 v[188:189], v[188:189], v[28:29]
    v_pk_add_f32 v[190:191], v[190:191], v[30:31]
    v_cvt_pk_bf16_f32 v52, v172, v188
    v_cvt_pk_bf16_f32 v53, v173, v189
    v_cvt_pk_bf16_f32 v54, v174, v190
    v_cvt_pk_bf16_f32 v55, v175, v191
    buffer_store_dword v52, v154, s[40:43], s10 offen offset:0 sc1
    buffer_store_dword v53, v154, s[40:43], s10 offen offset:1024 sc1
    buffer_store_dword v54, v154, s[40:43], s10 offen offset:2048 sc1
    buffer_store_dword v55, v154, s[40:43], s10 offen offset:3072 sc1
gated_mix__softmax_full_mha__softmax_full_mha__prompt_kernel_last:
gated_mix__softmax_full_mha__softmax_full_mha__prompt_kernel_exit:
    s_endpgm
gated_mix__softmax_full_mha__softmax_full_mha__prompt_kernel_add2:
    s_mov_b64 exec, 1
    buffer_atomic_add v161, off, s[32:35], s12 sc1
    s_mov_b64 exec, -1
    s_branch gated_mix__softmax_full_mha__softmax_full_mha__prompt_kernel_add2_back

gated_mix__softmax_full_mha__softmax_full_mha__prompt_kernel_extra:
    s_mov_b32 m0, s6
    s_add_u32 s59, s4, s5

    buffer_load_dwordx4 v1, s[32:35], s59 offen offset:0 sc1 lds
    buffer_load_dwordx4 v1, s[32:35], s59 offen offset:1024 sc1 lds
    buffer_load_dwordx4 v1, s[32:35], s59 offen offset:2048 sc1 lds
    buffer_load_dwordx4 v1, s[32:35], s59 offen offset:3072 sc1 lds
    s_add_u32 s5, s5, 32768
    s_and_b32 s5, s5, 0x3ffff
    s_lshl_b32 s61, s53, 15
    s_cmp_eq_u32 s5, s61
    s_cselect_b32 s61, 32768, 0
    s_add_u32 s5, s5, s61
    s_and_b32 s5, s5, 0x3ffff

    s_add_u32 s6, s6, 32768
    s_and_b32 s6, s6, 0x1ffff

    s_branch gated_mix__softmax_full_mha__softmax_full_mha__prompt_kernel_extra_back
gated_mix__softmax_full_mha__softmax_full_mha__prompt_kernel_late0:
    v_and_b32 v167, 7, v0
    v_lshlrev_b32 v167, 8, v167
    s_mov_b32 s60, 13770752
    buffer_load_dword v166, v167, s[32:35], s60 offen sc0 sc1
    s_branch gated_mix__softmax_full_mha__softmax_full_mha__prompt_kernel_late0_back

gated_mix__softmax_full_mha__softmax_full_mha__prompt_kernel_late6:
    s_waitcnt vmcnt(4)
gated_mix__softmax_full_mha__softmax_full_mha__prompt_kernel_all_chk:
    v_cmp_gt_u32 vcc, 32, v166
    s_cbranch_vccz gated_mix__softmax_full_mha__softmax_full_mha__prompt_kernel_late6_back
    s_add_u32 s18, s18, 1
    s_cmp_ge_u32 s18, 262144
    s_cbranch_scc1 gated_mix__softmax_full_mha__softmax_full_mha__prompt_kernel_late6_back
    buffer_load_dword v166, v167, s[32:35], s60 offen sc0 sc1
    s_waitcnt vmcnt(0)
    s_branch gated_mix__softmax_full_mha__softmax_full_mha__prompt_kernel_all_chk

gated_mix__softmax_full_mha__softmax_full_mha__prompt_kernel_safe:
    s_waitcnt vmcnt(0)
    s_lshl_b32 s62, s52, 18
    v_mov_b32 v104, 0xff800000
    v_mov_b32 v105, 0xff800000
    s_mov_b32 s8, 0

gated_mix__softmax_full_mha__softmax_full_mha__prompt_kernel_maxloop:
    s_lshr_b32 s60, s8, 3
    s_lshl_b32 s60, s60, 15
    s_and_b32 s61, s8, 7
    s_lshl_b32 s61, s61, 10
    s_add_u32 s60, s60, s61
    s_add_u32 s60, s60, s62

    buffer_load_dwordx4 v[16:19], v155, s[32:35], s60 offen sc1
    s_waitcnt vmcnt(0)
    v_mfma_f32_32x32x16_bf16 v[32:47], v[16:19], v[200:203], 0
    v_mfma_f32_32x32x16_bf16 v[48:63], v[16:19], v[204:207], 0
    s_nop 15
    v_max3_f32 v104, v32, v33, v104
    v_max3_f32 v104, v34, v35, v104
    v_max3_f32 v104, v36, v37, v104
    v_max3_f32 v104, v38, v39, v104
    v_max3_f32 v104, v40, v41, v104
    v_max3_f32 v104, v42, v43, v104
    v_max3_f32 v104, v44, v45, v104
    v_max3_f32 v104, v46, v47, v104
    v_max3_f32 v105, v48, v49, v105
    v_max3_f32 v105, v50, v51, v105
    v_max3_f32 v105, v52, v53, v105
    v_max3_f32 v105, v54, v55, v105
    v_max3_f32 v105, v56, v57, v105
    v_max3_f32 v105, v58, v59, v105
    v_max3_f32 v105, v60, v61, v105
    v_max3_f32 v105, v62, v63, v105
    s_add_u32 s8, s8, 1
    s_cmp_lg_u32 s8, 64
    s_cbranch_scc1 gated_mix__softmax_full_mha__softmax_full_mha__prompt_kernel_maxloop
    v_mov_b32 v106, v104
    v_mov_b32 v107, v105
    s_nop 1
    v_permlane32_swap_b32 v104, v106
    v_permlane32_swap_b32 v105, v107
    s_nop 1
    v_max_f32 v104, v104, v106
    v_max_f32 v105, v105, v107
    v_and_b32 v106, 0xb, v0
    v_cmp_eq_u32 vcc, 0, v106
    v_mov_b32 v107, 0x3f803f80
    v_mul_u32_u24 v167, v157, v156
    s_mov_b32 s8, 0

    v_cndmask_b32 v20, 0, v107, vcc
    v_cndmask_b32 v24, 0, v107, vcc
    v_cndmask_b32 v21, 0, v107, vcc
    v_cndmask_b32 v25, 0, v107, vcc
    v_cndmask_b32 v22, 0, v107, vcc
    v_cndmask_b32 v26, 0, v107, vcc
    v_cndmask_b32 v23, 0, v107, vcc
    v_cndmask_b32 v27, 0, v107, vcc
    v_sub_f32 v64, 0, v104
    v_mov_b32 v168, 0
    v_sub_f32 v65, 0, v104
    v_mov_b32 v169, 0
    v_sub_f32 v66, 0, v104
    v_mov_b32 v170, 0
    v_sub_f32 v67, 0, v104
    v_mov_b32 v171, 0
    v_sub_f32 v68, 0, v104
    v_mov_b32 v172, 0
    v_sub_f32 v69, 0, v104
    v_mov_b32 v173, 0
    v_sub_f32 v70, 0, v104
    v_mov_b32 v174, 0
    v_sub_f32 v71, 0, v104
    v_mov_b32 v175, 0
    v_sub_f32 v72, 0, v104
    v_mov_b32 v176, 0
    v_sub_f32 v73, 0, v104
    v_mov_b32 v177, 0
    v_sub_f32 v74, 0, v104
    v_mov_b32 v178, 0
    v_sub_f32 v75, 0, v104
    v_mov_b32 v179, 0
    v_sub_f32 v76, 0, v104
    v_mov_b32 v180, 0
    v_sub_f32 v77, 0, v104
    v_mov_b32 v181, 0
    v_sub_f32 v78, 0, v104
    v_mov_b32 v182, 0
    v_sub_f32 v79, 0, v104
    v_mov_b32 v183, 0
    v_sub_f32 v80, 0, v105
    v_mov_b32 v184, 0
    v_sub_f32 v81, 0, v105
    v_mov_b32 v185, 0
    v_sub_f32 v82, 0, v105
    v_mov_b32 v186, 0
    v_sub_f32 v83, 0, v105
    v_mov_b32 v187, 0
    v_sub_f32 v84, 0, v105
    v_mov_b32 v188, 0
    v_sub_f32 v85, 0, v105
    v_mov_b32 v189, 0
    v_sub_f32 v86, 0, v105
    v_mov_b32 v190, 0
    v_sub_f32 v87, 0, v105
    v_mov_b32 v191, 0
    v_sub_f32 v88, 0, v105
    v_mov_b32 v192, 0
    v_sub_f32 v89, 0, v105
    v_mov_b32 v193, 0
    v_sub_f32 v90, 0, v105
    v_mov_b32 v194, 0
    v_sub_f32 v91, 0, v105
    v_mov_b32 v195, 0
    v_sub_f32 v92, 0, v105
    v_mov_b32 v196, 0
    v_sub_f32 v93, 0, v105
    v_mov_b32 v197, 0
    v_sub_f32 v94, 0, v105
    v_mov_b32 v198, 0
    v_sub_f32 v95, 0, v105
    v_mov_b32 v199, 0
gated_mix__softmax_full_mha__softmax_full_mha__prompt_kernel_sumloop:
    s_lshr_b32 s60, s8, 3
    s_lshl_b32 s60, s60, 15
    s_and_b32 s61, s8, 7
    s_lshl_b32 s61, s61, 10
    s_add_u32 s60, s60, s61
    s_add_u32 s60, s60, s62

    buffer_load_dwordx4 v[16:19], v155, s[32:35], s60 offen sc1
    s_mov_b32 exec_lo, 0xffff
    s_mov_b32 exec_hi, 0xffff
    buffer_load_dwordx4 v[24:27], v167, s[32:35], s60 offen sc1
    buffer_load_dwordx4 v[20:23], v167, s[32:35], s60 offen offset:512 sc1
    s_mov_b64 exec, -1
    s_waitcnt vmcnt(0)

    v_mfma_f32_32x32x16_bf16 v[32:47], v[16:19], v[200:203], v[64:79]
    v_mfma_f32_32x32x16_bf16 v[48:63], v[16:19], v[204:207], v[80:95]
    s_nop 15
    v_exp_f32 v32, v32
    v_exp_f32 v33, v33
    v_exp_f32 v34, v34
    v_exp_f32 v35, v35
    v_exp_f32 v36, v36
    v_exp_f32 v37, v37
    v_exp_f32 v38, v38
    v_exp_f32 v39, v39
    v_exp_f32 v40, v40
    v_exp_f32 v41, v41
    v_exp_f32 v42, v42
    v_exp_f32 v43, v43
    v_exp_f32 v44, v44
    v_exp_f32 v45, v45
    v_exp_f32 v46, v46
    v_exp_f32 v47, v47
    s_nop 1
    v_smfmac_f32_32x32x32_bf16 v[168:183], v[24:27], v[32:39], v158
    v_smfmac_f32_32x32x32_bf16 v[168:183], v[20:23], v[40:47], v158
    v_exp_f32 v48, v48
    v_exp_f32 v49, v49
    v_exp_f32 v50, v50
    v_exp_f32 v51, v51
    v_exp_f32 v52, v52
    v_exp_f32 v53, v53
    v_exp_f32 v54, v54
    v_exp_f32 v55, v55
    v_exp_f32 v56, v56
    v_exp_f32 v57, v57
    v_exp_f32 v58, v58
    v_exp_f32 v59, v59
    v_exp_f32 v60, v60
    v_exp_f32 v61, v61
    v_exp_f32 v62, v62
    v_exp_f32 v63, v63
    s_nop 1
    v_smfmac_f32_32x32x32_bf16 v[184:199], v[24:27], v[48:55], v158
    v_smfmac_f32_32x32x32_bf16 v[184:199], v[20:23], v[56:63], v158
    s_nop 15
    s_add_u32 s8, s8, 1
    s_cmp_lg_u32 s8, 64
    s_cbranch_scc1 gated_mix__softmax_full_mha__softmax_full_mha__prompt_kernel_sumloop

    s_add_u32 s63, s14, 0
    s_and_b32 s63, s63, 0x7fff
    s_add_u32 s63, s63, s13
    buffer_load_dwordx4 v[64:67], v1, s[32:35], s63 offen offset:0
    buffer_load_dwordx4 v[68:71], v1, s[32:35], s63 offen offset:1024
    buffer_load_dwordx4 v[72:75], v1, s[32:35], s63 offen offset:2048
    buffer_load_dwordx4 v[76:79], v1, s[32:35], s63 offen offset:3072
    s_add_u32 s63, s14, 4096
    s_and_b32 s63, s63, 0x7fff
    s_add_u32 s63, s63, s13
    buffer_load_dwordx4 v[80:83], v1, s[32:35], s63 offen offset:0
    buffer_load_dwordx4 v[84:87], v1, s[32:35], s63 offen offset:1024
    buffer_load_dwordx4 v[88:91], v1, s[32:35], s63 offen offset:2048
    buffer_load_dwordx4 v[92:95], v1, s[32:35], s63 offen offset:3072
    s_add_u32 s63, s14, 8192
    s_and_b32 s63, s63, 0x7fff
    s_add_u32 s63, s63, s13
    buffer_load_dwordx4 v[96:99], v1, s[32:35], s63 offen offset:0
    buffer_load_dwordx4 v[100:103], v1, s[32:35], s63 offen offset:1024
    buffer_load_dwordx4 v[104:107], v1, s[32:35], s63 offen offset:2048
    buffer_load_dwordx4 v[108:111], v1, s[32:35], s63 offen offset:3072
    s_add_u32 s63, s14, 12288
    s_and_b32 s63, s63, 0x7fff
    s_add_u32 s63, s63, s13
    buffer_load_dwordx4 v[112:115], v1, s[32:35], s63 offen offset:0
    buffer_load_dwordx4 v[116:119], v1, s[32:35], s63 offen offset:1024
    buffer_load_dwordx4 v[120:123], v1, s[32:35], s63 offen offset:2048
    buffer_load_dwordx4 v[124:127], v1, s[32:35], s63 offen offset:3072
    s_add_u32 s63, s14, 16384
    s_and_b32 s63, s63, 0x7fff
    s_add_u32 s63, s63, s13
    buffer_load_dwordx4 v[128:131], v1, s[32:35], s63 offen offset:0
    buffer_load_dwordx4 v[132:135], v1, s[32:35], s63 offen offset:1024
    buffer_load_dwordx4 v[136:139], v1, s[32:35], s63 offen offset:2048
    buffer_load_dwordx4 v[140:143], v1, s[32:35], s63 offen offset:3072
    s_add_u32 s63, s14, 20480
    s_and_b32 s63, s63, 0x7fff
    s_add_u32 s63, s63, s13
    buffer_load_dwordx4 v[144:147], v1, s[32:35], s63 offen offset:0
    buffer_load_dwordx4 v[148:151], v1, s[32:35], s63 offen offset:1024
    buffer_load_dwordx4 v[208:211], v1, s[32:35], s63 offen offset:2048
    buffer_load_dwordx4 v[212:215], v1, s[32:35], s63 offen offset:3072
    s_add_u32 s63, s14, 24576
    s_and_b32 s63, s63, 0x7fff
    s_add_u32 s63, s63, s13
    buffer_load_dwordx4 v[216:219], v1, s[32:35], s63 offen offset:0
    buffer_load_dwordx4 v[220:223], v1, s[32:35], s63 offen offset:1024
    buffer_load_dwordx4 v[224:227], v1, s[32:35], s63 offen offset:2048
    buffer_load_dwordx4 v[228:231], v1, s[32:35], s63 offen offset:3072
    s_add_u32 s63, s14, 28672
    s_and_b32 s63, s63, 0x7fff
    s_add_u32 s63, s63, s13
    buffer_load_dwordx4 v[232:235], v1, s[32:35], s63 offen offset:0
    buffer_load_dwordx4 v[236:239], v1, s[32:35], s63 offen offset:1024
    buffer_load_dwordx4 v[240:243], v1, s[32:35], s63 offen offset:2048
    buffer_load_dwordx4 v[244:247], v1, s[32:35], s63 offen offset:3072
    s_branch gated_mix__softmax_full_mha__softmax_full_mha__prompt_kernel_fin
.section .rodata,"a"
.p2align 6
.amdhsa_kernel gated_mix__softmax_full_mha__softmax_full_mha__prompt_kernel
  .amdhsa_next_free_vgpr 256
  .amdhsa_next_free_sgpr 102
  .amdhsa_accum_offset 256
  .amdhsa_group_segment_fixed_size 0
  .amdhsa_kernarg_size 80
  .amdhsa_user_sgpr_count 2
  .amdhsa_user_sgpr_kernarg_segment_ptr 1
  .amdhsa_system_sgpr_workgroup_id_x 1
  .amdhsa_float_denorm_mode_32 3
.end_amdhsa_kernel
```
